```python
import torch

def _softmax(x, axis=-1):
    return torch.softmax(x, dim=axis)
def _gelu(x):
    return torch.nn.functional.gelu(x, approximate="tanh")
def _silu(x):
    return torch.nn.functional.silu(x)
def _sigmoid(x):
    return torch.sigmoid(x)
def _layernorm(x, axis=-1, eps=1e-5):
    m = x.mean(dim=axis, keepdim=True)
    v = x.var(dim=axis, keepdim=True, unbiased=False)
    return (x - m) / torch.sqrt(v + eps)
def _scatter_add(tgt, idx, src, axis=0):
    return tgt.clone().index_add_(axis, idx, src)
def _segment_sum(src, seg, n):
    out = torch.zeros((n,) + src.shape[1:], dtype=src.dtype)
    return out.index_add_(0, seg, src)
def _pad(x, pw):
    flat = tuple(v for pair in reversed(pw) for v in pair)
    return torch.nn.functional.pad(x, flat)

kernel_name = 'concat_heads__spectral_fnet__sliding_block__prompt'

def setup_inputs():

    _w = (lambda a: (lambda t: t.to(torch.bfloat16) if t.is_floating_point() else t)(torch.as_tensor(a)))
    def _A_setup():
        B, S, D = 1, 2048, 448
        ns = torch.arange(S)[:, None] * torch.arange(S)[None, :]
        nd = torch.arange(D)[:, None] * torch.arange(D)[None, :]
        Ws_re = torch.cos(-2.0 * torch.pi * ns / S).to(float)
        Ws_im = torch.sin(-2.0 * torch.pi * ns / S).to(float)
        Wd_re = torch.cos(-2.0 * torch.pi * nd / D).to(float)
        Wd_im = torch.sin(-2.0 * torch.pi * nd / D).to(float)
        return {
            "x": _w((lambda *s: torch.randn(*s, dtype=torch.bfloat16) * 0.05)(B, S, D)),
            "dft_seq_re": _w(Ws_re),
            "dft_seq_im": _w(Ws_im),
            "dft_hid_re": _w(Wd_re),
            "dft_hid_im": _w(Wd_im),
        }
    _A_in = _A_setup()

    def _B_setup():
        B, S, D = 1, 2048, 448
        return {
            "x": _w((lambda *s: torch.randn(*s, dtype=torch.bfloat16) * 0.2)(B, S, D)),
            "wqkv": _w((lambda *s: torch.randn(*s, dtype=torch.bfloat16) * 0.8)(D, 3 * D)),
            "wo": _w((lambda *s: torch.randn(*s, dtype=torch.bfloat16) * 0.2)(D, D)),
        }
    _B_in = _B_setup()

    return {
        "A_x": _A_in["x"],
        "A_dft_seq_re": _A_in["dft_seq_re"],
        "A_dft_seq_im": _A_in["dft_seq_im"],
        "A_dft_hid_re": _A_in["dft_hid_re"],
        "A_dft_hid_im": _A_in["dft_hid_im"],
        "B_x": _B_in["x"],
        "B_wqkv": _B_in["wqkv"],
        "B_wo": _B_in["wo"],
    }

def reference(A_x, A_dft_seq_re, A_dft_seq_im, A_dft_hid_re, A_dft_hid_im, B_x, B_wqkv, B_wo):
    def _A_ref(x, dft_seq_re, dft_seq_im, dft_hid_re, dft_hid_im):
        a = torch.einsum("bsd,ed->bse", x, dft_hid_re)
        b = torch.einsum("bsd,ed->bse", x, dft_hid_im)
        y = torch.einsum("ts,bse->bte", dft_seq_re, a) - torch.einsum("ts,bse->bte", dft_seq_im, b)
        return y

    def _B_ref(x, wqkv, wo):
        B, S, D = x.shape
        H = 16; Dh = D // H; W = 256
        qkv = (lambda x, *d: x.permute(*d))((x @ wqkv).reshape(B, S, 3, H, Dh), 2, 0, 3, 1, 4)
        q, k, v = qkv[0], qkv[1], qkv[2]
        scores = torch.einsum("bhqd,bhkd->bhqk", q, k) * (Dh ** -0.5)
        idx = torch.arange(S)
        mask = (idx[:, None] - idx[None, :] >= 0) & (idx[:, None] - idx[None, :] < W)
        scores = torch.where(mask[None, None], scores, -1e9)
        p = _softmax(scores, axis=-1)
        o = torch.einsum("bhqk,bhkd->bhqd", p, v)
        return (lambda x, *d: x.permute(*d))(o, 0, 2, 1, 3).reshape(B, S, D) @ wo

    a = _A_ref(A_x, A_dft_seq_re, A_dft_seq_im, A_dft_hid_re, A_dft_hid_im)
    b = _B_ref(B_x, B_wqkv, B_wo)
    return torch.concatenate([a, b], axis=-1)
```

```asm
; @launch grid=(256,1,1) block=(512,1,1) lds=160768
.amdgcn_target "amdgcn-amd-amdhsa--gfx950"
.text
.globl concat_heads__spectral_fnet__sliding_block__prompt_kernel
.p2align 8
.type concat_heads__spectral_fnet__sliding_block__prompt_kernel,@function
concat_heads__spectral_fnet__sliding_block__prompt_kernel:
    s_cmp_ge_u32 s2, 256
    s_cbranch_scc1 L_end
    s_getpc_b64 s[46:47]
    s_load_dwordx16 s[4:19], s[0:1], 0
    s_load_dwordx4 s[20:23], s[0:1], 64
    s_load_dwordx2 s[24:25], s[0:1], 80
    v_lshrrev_b32 v1, 6, v0
    s_lshr_b32 s33, s2, 3
    v_readfirstlane_b32 s3, v1
    s_nop 0
    s_lshl3_add_u32 s38, s33, s3
    s_lshl_b32 s38, s38, 7
    s_min_u32 s38, s38, L_end-concat_heads__spectral_fnet__sliding_block__prompt_kernel-64
    v_mov_b32 v1, s38
    v_and_b32 v0, 63, v0
    global_load_dword v255, v1, s[46:47]
    s_and_b32 s32, s2, 7
    s_lshr_b32 s36, s33, 2
    s_and_b32 s38, s33, 3
    s_lshr_b32 s39, s32, 1
    s_lshl2_add_u32 s34, s39, s38
    s_and_b32 s40, s32, 1
    s_lshl3_add_u32 s35, s40, s36
    s_sub_u32 s41, 6, s40
    s_cmp_gt_u32 s36, s41
    s_subb_u32 s44, s36, 0
    s_cmp_lg_u32 s36, s41
    s_cselect_b32 s43, 1, 0
    s_cselect_b32 s41, 57344, 0
    s_mov_b32 s28, 0x6543210
    s_mov_b32 s29, 0x10654321
    s_lshl1_add_u32 s45, s38, s44
    s_lshl_b32 s45, s45, 2
    s_lshr_b64 s[28:29], s[28:29], s45
    s_and_b32 s45, s28, 7
    s_lshl_b32 s45, s45, 2
    s_mov_b32 s28, 0x06543210
    s_mov_b32 s29, 0x00654321
    s_lshr_b64 s[28:29], s[28:29], s45
    s_and_b32 s37, s3, 3
    v_lshrrev_b32 v3, 3, v0
    v_lshrrev_b32 v4, 4, v0
    v_and_b32 v5, 7, v0
    v_xor_b32 v6, v5, v4
    v_lshlrev_b32 v6, 4, v6
    v_mul_u32_u24 v2, 896, v3
    v_add_u32_e64 v8, v2, v6
    v_xor_b32 v9, 64, v8
    v_add_u32 v9, 6144, v9
    v_add_u32 v10, 12288, v8
    v_add_u32 v11, 12288, v9
    s_lshl2_add_u32 s54, s34, s37
    s_mul_i32 s52, s54, 28672
    s_lshl_b32 s53, s37, 12
    s_add_u32 s53, s53, s41
    s_mov_b32 s50, 1835008
    s_mov_b32 s51, 0x20000
    s_mov_b32 s26, 8388608
    s_mov_b32 s27, 0x20000
    s_cmp_ge_u32 s3, 4
    s_cbranch_scc0 L_B
L_A:
    v_lshlrev_b32 v7, 2, v4
    v_and_b32 v7, 4, v7
    v_xor_b32_e64 v7, v7, v5
    v_mul_u32_u24 v12, 2688, v3
    v_lshl_add_u32 v12, v7, 4, v12
    v_add_u32 v13, 20480, v12
    s_mul_i32 s39, s40, 7
    s_add_u32 s39, s39, s44
    s_add_u32 s39, s39, 7
    s_mov_b32 s58, 1204224
    s_lshl_b32 s39, s39, 7
    s_mul_i32 s74, s37, 43008
    s_add_u32 s55, s74, s39
    s_lshl_b32 s72, s37, 11
    s_mov_b32 s59, 0x20000
    s_waitcnt lgkmcnt(0)
    s_mov_b32 s1, s28
    s_mov_b32 s48, s14
    s_mov_b32 s49, s15
    s_mov_b32 s56, s16
    s_mov_b32 s57, s17
    s_cmp_eq_u32 s43, 0
    s_cbranch_scc1 L_A_P
    s_add_u32 m0, s72, 0
    s_bfe_u32 s45, s1, 0x30000
    s_mul_i32 s45, s45, 172032
    s_add_u32 s45, s45, s55
    buffer_load_dwordx4 v12, s[56:59], s45 offen offset:0 lds
    buffer_load_dwordx4 v13, s[56:59], s45 offen offset:1024 lds
    s_add_u32 m0, s72, 8192
    s_bfe_u32 s45, s1, 0x30004
    s_mul_i32 s45, s45, 172032
    s_add_u32 s45, s45, s55
    buffer_load_dwordx4 v12, s[56:59], s45 offen offset:0 lds
    buffer_load_dwordx4 v13, s[56:59], s45 offen offset:1024 lds
    s_branch L_A2
L_B:
    v_lshlrev_b32 v18, 4, v0
    s_lshl2_add_u32 s33, s44, s38
    s_waitcnt lgkmcnt(0)
    s_mov_b32 s1, s28
    s_mov_b32 s48, s14
    s_mov_b32 s49, s15
    s_cmp_eq_u32 s43, 0
    s_cbranch_scc1 L_B_clear
    s_add_u32 m0, s53, 0
    s_bfe_u32 s45, s1, 0x30000
    s_mul_i32 s45, s45, 128
    s_add_u32 s45, s45, s52
    buffer_load_dwordx4 v8, s[48:51], s45 offen offset:0 lds
    buffer_load_dwordx4 v9, s[48:51], s45 offen offset:1024 lds
    buffer_load_dwordx4 v10, s[48:51], s45 offen offset:2048 lds
    buffer_load_dwordx4 v11, s[48:51], s45 offen offset:3072 lds
L_B_cleared:
    s_mov_b32 s0, 1
    s_add_u32 s46, s24, 1835008
    s_addc_u32 s47, s25, 0
    s_mov_b32 s28, s20
    s_mov_b32 s29, s21
    s_mov_b32 s30, 3670016
    s_mov_b32 s31, 0x20000
    s_mov_b64 s[100:101], s[16:17]
    v_and_b32 v22, 31, v0
    v_lshrrev_b32_e64 v23, 5, v0
    v_bfe_u32 v32, v0, 1, 3
    v_xor_b32 v32, v32, v23
    v_lshlrev_b32 v32, 4, v32
    v_lshl_add_u32 v32, v22, 7, v32
    v_add_u32 v12, s53, v32
    v_xor_b32 v13, 32, v12
    v_xor_b32_e64 v14, 64, v12
    v_xor_b32 v15, 96, v12
    v_bfe_u32 v33, v0, 2, 2
    v_lshl_add_u32 v34, v23, 3, v33
    v_bfe_u32 v35, v0, 4, 1
    v_and_b32_e64 v36, 1, v0
    v_bfe_u32 v37, v0, 1, 1
    v_lshl_add_u32 v36, v36, 1, v37
    v_lshl_add_u32 v36, v35, 2, v36
    v_and_b32_e64 v30, 3, v0
    v_lshl_add_u32 v37, v35, 2, v30
    v_lshlrev_b32_e64 v7, 3, v36
    v_lshl_add_u32 v7, v34, 6, v7
    v_add_u32 v7, 131072, v7
    s_bitcmp1_b32 s32, 0
    s_cselect_b64 vcc, -1, 0
    v_cndmask_b32 v36, v36, v37, vcc
    v_lshlrev_b32 v36, 3, v36
    v_lshl_add_u32 v36, v34, 7, v36
    v_bfe_u32 v37, v0, 3, 1
    v_lshl_add_u32 v16, v37, 6, v36
    v_xor_b32 v17, 64, v16
    v_lshlrev_b32 v19, 2, v30
    v_add_u32 v19, 159760, v19
    s_lshl2_add_u32 s38, s37, 159760
    v_mov_b32_e64 v21, s38
    v_mul_u32_u24 v6, 7168, v23
    v_lshl_add_u32 v6, v22, 4, v6
    v_add_u32 v5, 13312, v6
    s_lshl_b32 s38, s37, 11
    v_add_u32 v4, s38, v18
    v_mov_b32 v25, 2
    v_mov_b32 v26, 1
    v_mov_b32_e64 v24, 0
    s_cmp_ge_u32 s44, 4
    s_addc_u32 s77, s44, s44
    s_lshl4_add_u32 s77, s34, s77
    s_lshl_b32 s77, s77, 8
    s_add_u32 s77, s77, 1835008
    v_and_b32 v32, 12, v0
    s_add_u32 s38, s37, 8
    v_sub_u32 v33, s38, v32
    v_mul_u32_u24 v33, 22, v33
    v_and_b32 v33, 0xc0, v33
    v_lshl_add_u32 v33, v32, 10, v33
    v_lshl_add_u32 v2, v30, 8, v33
    s_cmp_eq_u32 s44, 3
    s_cselect_b32 s72, 0x888, 0
    s_or_b32 s72, s72, 0x777
    s_mul_i32 s53, s37, 3
    s_lshl2_add_u32 s78, s34, s53
    s_lshl_b32 s53, s53, 11
    v_lshrrev_b32_e64 v32, 2, v0
    v_lshl_add_u32 v33, v30, 4, s53
    v_lshl_add_u32 v3, v32, 9, v33
    v_mul_u32_u24 v32, 2688, v32
    v_lshl_add_u32 v89, v30, 4, v32
    v_lshrrev_b32 v33, 4, v0
    v_add_u32 v33, s78, v33
    v_cmp_le_u32 s[56:57], 8, v33
    v_cmp_eq_u32_e64 vcc, 0, v30
    v_mov_b32 v93, 0x3f803f80
    s_and_b64 vcc, vcc, s[56:57]
    s_mul_i32 s38, s35, 7
    v_cndmask_b32 v92, 0, v93, vcc
    v_cndmask_b32 v93, 0, v93, vcc
    v_mov_b64 v[94:95], v[92:93]
    s_lshr_b32 s38, s38, 1
    s_mul_i32 s39, s37, 43008
    s_lshl4_add_u32 s34, s38, s39
    s_lshl_b32 s82, s37, 10
    v_and_b32_e64 v33, 4, v0
    v_lshl_add_u32 v88, v33, 3, v19
    s_min_u32 s55, s54, 7
    s_mov_b32 s80, 0
    s_cmp_eq_u32 s43, 0
    s_cbranch_scc1 L_B_N
    s_lshl_b32 s38, s37, 12
    s_add_u32 s38, s38, 57344
    s_add_u32 m0, s38, 16384
    s_bfe_u32 s45, s1, 0x30004
    s_mul_i32 s45, s45, 128
    s_add_u32 s45, s45, s52
    buffer_load_dwordx4 v8, s[48:51], s45 offen offset:0 lds
    buffer_load_dwordx4 v9, s[48:51], s45 offen offset:1024 lds
    buffer_load_dwordx4 v10, s[48:51], s45 offen offset:2048 lds
    buffer_load_dwordx4 v11, s[48:51], s45 offen offset:3072 lds
    s_setprio 1
    s_bitcmp1_b32 s32, 0
    s_cbranch_scc1 L_B_V
    s_lshl_b32 s39, s44, 12
    s_add_u32 s81, s52, s39
    s_waitcnt vmcnt(4)
    s_barrier
    ds_read_b128 v[128:131], v12 offset:0
    ds_read_b128 v[132:135], v13 offset:0
    ds_read_b128 v[136:139], v14 offset:0
    ds_read_b128 v[140:143], v15 offset:0
    ds_read_b64_tr_b16 v[64:65], v16 offset:0
    ds_read_b64_tr_b16 v[66:67], v16 offset:512
    ds_read_b64_tr_b16 v[68:69], v17 offset:0
    ds_read_b64_tr_b16 v[70:71], v17 offset:512
    ds_read_b64_tr_b16 v[72:73], v16 offset:2048
    ds_read_b64_tr_b16 v[74:75], v16 offset:2560
    ds_read_b64_tr_b16 v[76:77], v17 offset:2048
    ds_read_b64_tr_b16 v[78:79], v17 offset:2560
    s_waitcnt lgkmcnt(4)
    v_mfma_f32_32x32x16_bf16 v[96:111], v[64:67], v[128:131], 0
    ds_read_b64_tr_b16 v[80:81], v16 offset:4096
    ds_read_b64_tr_b16 v[82:83], v16 offset:4608
    ds_read_b64_tr_b16 v[84:85], v17 offset:4096
    ds_read_b64_tr_b16 v[86:87], v17 offset:4608
    v_mfma_f32_32x32x16_bf16 v[112:127], v[68:71], v[128:131], 0
    s_waitcnt lgkmcnt(4)
    v_mfma_f32_32x32x16_bf16 v[96:111], v[72:75], v[132:135], v[96:111]
    ds_read_b64_tr_b16 v[64:65], v16 offset:6144
    ds_read_b64_tr_b16 v[66:67], v16 offset:6656
    ds_read_b64_tr_b16 v[68:69], v17 offset:6144
    ds_read_b64_tr_b16 v[70:71], v17 offset:6656
    v_mfma_f32_32x32x16_bf16 v[112:127], v[76:79], v[132:135], v[112:127]
    s_waitcnt lgkmcnt(4)
    v_mfma_f32_32x32x16_bf16 v[96:111], v[80:83], v[136:139], v[96:111]
    s_waitcnt vmcnt(0)
    s_barrier
    ds_read_b128 v[144:147], v12 offset:16384
    ds_read_b128 v[148:151], v13 offset:16384
    ds_read_b128 v[152:155], v14 offset:16384
    ds_read_b128 v[156:159], v15 offset:16384
    ds_read_b64_tr_b16 v[72:73], v16 offset:8192
    ds_read_b64_tr_b16 v[74:75], v16 offset:8704
    ds_read_b64_tr_b16 v[76:77], v17 offset:8192
    ds_read_b64_tr_b16 v[78:79], v17 offset:8704
    v_mfma_f32_32x32x16_bf16 v[112:127], v[84:87], v[136:139], v[112:127]
    s_waitcnt lgkmcnt(8)
    v_mfma_f32_32x32x16_bf16 v[96:111], v[64:67], v[140:143], v[96:111]
    ds_read_b64_tr_b16 v[80:81], v16 offset:10240
    ds_read_b64_tr_b16 v[82:83], v16 offset:10752
    ds_read_b64_tr_b16 v[84:85], v17 offset:10240
    ds_read_b64_tr_b16 v[86:87], v17 offset:10752
    v_mfma_f32_32x32x16_bf16 v[112:127], v[68:71], v[140:143], v[112:127]
    s_waitcnt lgkmcnt(4)
    v_mfma_f32_32x32x16_bf16 v[96:111], v[72:75], v[144:147], v[96:111]
    ds_read_b64_tr_b16 v[64:65], v16 offset:12288
    ds_read_b64_tr_b16 v[66:67], v16 offset:12800
    ds_read_b64_tr_b16 v[68:69], v17 offset:12288
    ds_read_b64_tr_b16 v[70:71], v17 offset:12800
    v_mfma_f32_32x32x16_bf16 v[112:127], v[76:79], v[144:147], v[112:127]
    s_waitcnt lgkmcnt(4)
    v_mfma_f32_32x32x16_bf16 v[96:111], v[80:83], v[148:151], v[96:111]
    ds_read_b64_tr_b16 v[72:73], v16 offset:14336
    ds_read_b64_tr_b16 v[74:75], v16 offset:14848
    ds_read_b64_tr_b16 v[76:77], v17 offset:14336
    ds_read_b64_tr_b16 v[78:79], v17 offset:14848
    v_mfma_f32_32x32x16_bf16 v[112:127], v[84:87], v[148:151], v[112:127]
    s_waitcnt lgkmcnt(4)
    v_mfma_f32_32x32x16_bf16 v[96:111], v[64:67], v[152:155], v[96:111]
    s_barrier
    ds_read_b128 v[160:163], v12 offset:32768
    ds_read_b128 v[164:167], v13 offset:32768
    ds_read_b128 v[168:171], v14 offset:32768
    ds_read_b128 v[172:175], v15 offset:32768
    ds_read_b64_tr_b16 v[80:81], v16 offset:16384
    ds_read_b64_tr_b16 v[82:83], v16 offset:16896
    ds_read_b64_tr_b16 v[84:85], v17 offset:16384
    ds_read_b64_tr_b16 v[86:87], v17 offset:16896
    v_mfma_f32_32x32x16_bf16 v[112:127], v[68:71], v[152:155], v[112:127]
    s_waitcnt lgkmcnt(8)
    v_mfma_f32_32x32x16_bf16 v[96:111], v[72:75], v[156:159], v[96:111]
    ds_read_b64_tr_b16 v[64:65], v16 offset:18432
    ds_read_b64_tr_b16 v[66:67], v16 offset:18944
    ds_read_b64_tr_b16 v[68:69], v17 offset:18432
    ds_read_b64_tr_b16 v[70:71], v17 offset:18944
    v_mfma_f32_32x32x16_bf16 v[112:127], v[76:79], v[156:159], v[112:127]
    s_waitcnt lgkmcnt(4)
    v_mfma_f32_32x32x16_bf16 v[96:111], v[80:83], v[160:163], v[96:111]
    ds_read_b64_tr_b16 v[72:73], v16 offset:20480
    ds_read_b64_tr_b16 v[74:75], v16 offset:20992
    ds_read_b64_tr_b16 v[76:77], v17 offset:20480
    ds_read_b64_tr_b16 v[78:79], v17 offset:20992
    v_mfma_f32_32x32x16_bf16 v[112:127], v[84:87], v[160:163], v[112:127]
    s_waitcnt lgkmcnt(4)
    v_mfma_f32_32x32x16_bf16 v[96:111], v[64:67], v[164:167], v[96:111]
    ds_read_b64_tr_b16 v[80:81], v16 offset:22528
    ds_read_b64_tr_b16 v[82:83], v16 offset:23040
    ds_read_b64_tr_b16 v[84:85], v17 offset:22528
    ds_read_b64_tr_b16 v[86:87], v17 offset:23040
    v_mfma_f32_32x32x16_bf16 v[112:127], v[68:71], v[164:167], v[112:127]
    s_waitcnt lgkmcnt(4)
    v_mfma_f32_32x32x16_bf16 v[96:111], v[72:75], v[168:171], v[96:111]
    s_barrier
    v_add_u32 v8, 49152, v12
    v_add_u32 v9, 49152, v13
    v_add_u32 v10, 49152, v14
    v_add_u32 v11, 49152, v15
    ds_read_b128 v[176:179], v8 offset:0
    ds_read_b128 v[180:183], v9 offset:0
    ds_read_b128 v[184:187], v10 offset:0
    ds_read_b128 v[188:191], v11 offset:0
    ds_read_b64_tr_b16 v[64:65], v16 offset:24576
    ds_read_b64_tr_b16 v[66:67], v16 offset:25088
    ds_read_b64_tr_b16 v[68:69], v17 offset:24576
    ds_read_b64_tr_b16 v[70:71], v17 offset:25088
    v_mfma_f32_32x32x16_bf16 v[112:127], v[76:79], v[168:171], v[112:127]
    s_waitcnt lgkmcnt(8)
    v_mfma_f32_32x32x16_bf16 v[96:111], v[80:83], v[172:175], v[96:111]
    ds_read_b64_tr_b16 v[72:73], v16 offset:26624
    ds_read_b64_tr_b16 v[74:75], v16 offset:27136
    ds_read_b64_tr_b16 v[76:77], v17 offset:26624
    ds_read_b64_tr_b16 v[78:79], v17 offset:27136
    v_mfma_f32_32x32x16_bf16 v[112:127], v[84:87], v[172:175], v[112:127]
    s_waitcnt lgkmcnt(4)
    v_mfma_f32_32x32x16_bf16 v[96:111], v[64:67], v[176:179], v[96:111]
    ds_read_b64_tr_b16 v[80:81], v16 offset:28672
    ds_read_b64_tr_b16 v[82:83], v16 offset:29184
    ds_read_b64_tr_b16 v[84:85], v17 offset:28672
    ds_read_b64_tr_b16 v[86:87], v17 offset:29184
    v_mfma_f32_32x32x16_bf16 v[112:127], v[68:71], v[176:179], v[112:127]
    s_waitcnt lgkmcnt(4)
    v_mfma_f32_32x32x16_bf16 v[96:111], v[72:75], v[180:183], v[96:111]
    ds_read_b64_tr_b16 v[64:65], v16 offset:30720
    ds_read_b64_tr_b16 v[66:67], v16 offset:31232
    ds_read_b64_tr_b16 v[68:69], v17 offset:30720
    ds_read_b64_tr_b16 v[70:71], v17 offset:31232
    v_mfma_f32_32x32x16_bf16 v[112:127], v[76:79], v[180:183], v[112:127]
    s_waitcnt lgkmcnt(4)
    v_mfma_f32_32x32x16_bf16 v[96:111], v[80:83], v[184:187], v[96:111]
    s_barrier
    ds_read_b128 v[192:195], v8 offset:16384
    ds_read_b128 v[196:199], v9 offset:16384
    ds_read_b128 v[200:203], v10 offset:16384
    ds_read_b128 v[204:207], v11 offset:16384
    ds_read_b64_tr_b16 v[72:73], v16 offset:32768
    ds_read_b64_tr_b16 v[74:75], v16 offset:33280
    ds_read_b64_tr_b16 v[76:77], v17 offset:32768
    ds_read_b64_tr_b16 v[78:79], v17 offset:33280
    v_mfma_f32_32x32x16_bf16 v[112:127], v[84:87], v[184:187], v[112:127]
    s_waitcnt lgkmcnt(8)
    v_mfma_f32_32x32x16_bf16 v[96:111], v[64:67], v[188:191], v[96:111]
    ds_read_b64_tr_b16 v[80:81], v16 offset:34816
    ds_read_b64_tr_b16 v[82:83], v16 offset:35328
    ds_read_b64_tr_b16 v[84:85], v17 offset:34816
    ds_read_b64_tr_b16 v[86:87], v17 offset:35328
    v_mfma_f32_32x32x16_bf16 v[112:127], v[68:71], v[188:191], v[112:127]
    s_waitcnt lgkmcnt(4)
    v_mfma_f32_32x32x16_bf16 v[96:111], v[72:75], v[192:195], v[96:111]
    ds_read_b64_tr_b16 v[64:65], v16 offset:36864
    ds_read_b64_tr_b16 v[66:67], v16 offset:37376
    ds_read_b64_tr_b16 v[68:69], v17 offset:36864
    ds_read_b64_tr_b16 v[70:71], v17 offset:37376
    v_mfma_f32_32x32x16_bf16 v[112:127], v[76:79], v[192:195], v[112:127]
    s_waitcnt lgkmcnt(4)
    v_mfma_f32_32x32x16_bf16 v[96:111], v[80:83], v[196:199], v[96:111]
    ds_read_b64_tr_b16 v[72:73], v16 offset:38912
    ds_read_b64_tr_b16 v[74:75], v16 offset:39424
    ds_read_b64_tr_b16 v[76:77], v17 offset:38912
    ds_read_b64_tr_b16 v[78:79], v17 offset:39424
    v_mfma_f32_32x32x16_bf16 v[112:127], v[84:87], v[196:199], v[112:127]
    s_waitcnt lgkmcnt(4)
    v_mfma_f32_32x32x16_bf16 v[96:111], v[64:67], v[200:203], v[96:111]
    s_barrier
    global_load_dword v90, v24, s[22:23] offset:128 sc1
    ds_read_b128 v[208:211], v8 offset:32768
    ds_read_b128 v[212:215], v9 offset:32768
    ds_read_b128 v[216:219], v10 offset:32768
    ds_read_b128 v[220:223], v11 offset:32768
    ds_read_b64_tr_b16 v[80:81], v16 offset:40960
    ds_read_b64_tr_b16 v[82:83], v16 offset:41472
    ds_read_b64_tr_b16 v[84:85], v17 offset:40960
    ds_read_b64_tr_b16 v[86:87], v17 offset:41472
    v_mfma_f32_32x32x16_bf16 v[112:127], v[68:71], v[200:203], v[112:127]
    s_waitcnt lgkmcnt(8)
    v_mfma_f32_32x32x16_bf16 v[96:111], v[72:75], v[204:207], v[96:111]
    ds_read_b64_tr_b16 v[64:65], v16 offset:43008
    ds_read_b64_tr_b16 v[66:67], v16 offset:43520
    ds_read_b64_tr_b16 v[68:69], v17 offset:43008
    ds_read_b64_tr_b16 v[70:71], v17 offset:43520
    v_mfma_f32_32x32x16_bf16 v[112:127], v[76:79], v[204:207], v[112:127]
    s_waitcnt lgkmcnt(4)
    v_mfma_f32_32x32x16_bf16 v[96:111], v[80:83], v[208:211], v[96:111]
    ds_read_b64_tr_b16 v[72:73], v16 offset:45056
    ds_read_b64_tr_b16 v[74:75], v16 offset:45568
    ds_read_b64_tr_b16 v[76:77], v17 offset:45056
    ds_read_b64_tr_b16 v[78:79], v17 offset:45568
    v_mfma_f32_32x32x16_bf16 v[112:127], v[84:87], v[208:211], v[112:127]
    s_waitcnt lgkmcnt(4)
    v_mfma_f32_32x32x16_bf16 v[96:111], v[64:67], v[212:215], v[96:111]
    ds_read_b64_tr_b16 v[80:81], v16 offset:47104
    ds_read_b64_tr_b16 v[82:83], v16 offset:47616
    ds_read_b64_tr_b16 v[84:85], v17 offset:47104
    ds_read_b64_tr_b16 v[86:87], v17 offset:47616
    v_mfma_f32_32x32x16_bf16 v[112:127], v[68:71], v[212:215], v[112:127]
    s_waitcnt lgkmcnt(4)
    v_mfma_f32_32x32x16_bf16 v[96:111], v[72:75], v[216:219], v[96:111]
    ds_read_b64_tr_b16 v[32:33], v16 offset:49152
    ds_read_b64_tr_b16 v[34:35], v16 offset:49664
    ds_read_b64_tr_b16 v[36:37], v17 offset:49152
    ds_read_b64_tr_b16 v[38:39], v17 offset:49664
    v_mfma_f32_32x32x16_bf16 v[112:127], v[76:79], v[216:219], v[112:127]
    ds_read_b64_tr_b16 v[40:41], v16 offset:51200
    ds_read_b64_tr_b16 v[42:43], v16 offset:51712
    ds_read_b64_tr_b16 v[44:45], v17 offset:51200
    ds_read_b64_tr_b16 v[46:47], v17 offset:51712
    s_waitcnt lgkmcnt(8)
    v_mfma_f32_32x32x16_bf16 v[96:111], v[80:83], v[220:223], v[96:111]
    ds_read_b64_tr_b16 v[48:49], v16 offset:53248
    ds_read_b64_tr_b16 v[50:51], v16 offset:53760
    ds_read_b64_tr_b16 v[52:53], v17 offset:53248
    ds_read_b64_tr_b16 v[54:55], v17 offset:53760
    v_mfma_f32_32x32x16_bf16 v[112:127], v[84:87], v[220:223], v[112:127]
    s_waitcnt lgkmcnt(8)
    ds_read_b64_tr_b16 v[56:57], v16 offset:55296
    ds_read_b64_tr_b16 v[58:59], v16 offset:55808
    ds_read_b64_tr_b16 v[60:61], v17 offset:55296
    ds_read_b64_tr_b16 v[62:63], v17 offset:55808
    s_waitcnt lgkmcnt(8)
    s_barrier
    ds_read_b128 v[224:227], v12
    ds_read_b128 v[228:231], v13
    ds_read_b128 v[232:235], v14
    ds_read_b128 v[236:239], v15
    s_waitcnt lgkmcnt(3)
    v_mfma_f32_32x32x16_bf16 v[96:111], v[32:35], v[224:227], v[96:111]
    s_waitcnt lgkmcnt(2)
    v_mfma_f32_32x32x16_bf16 v[96:111], v[40:43], v[228:231], v[96:111]
    s_waitcnt lgkmcnt(1)
    v_mfma_f32_32x32x16_bf16 v[96:111], v[48:51], v[232:235], v[96:111]
    s_waitcnt lgkmcnt(0)
    v_mfma_f32_32x32x16_bf16 v[96:111], v[56:59], v[236:239], v[96:111]
    v_mfma_f32_32x32x16_bf16 v[112:127], v[36:39], v[224:227], v[112:127]
    s_nop 5
    v_mfma_f32_32x32x16_bf16 v[112:127], v[44:47], v[228:231], v[112:127]
    s_nop 3
    v_cvt_pk_bf16_f32 v64, v96, v97
    v_cvt_pk_bf16_f32 v65, v98, v99
    v_cvt_pk_bf16_f32 v66, v100, v101
    v_cvt_pk_bf16_f32 v67, v102, v103
    buffer_store_dwordx4 v[64:67], v18, s[24:27], s81 offen offset:0 sc1
    v_mfma_f32_32x32x16_bf16 v[112:127], v[52:55], v[232:235], v[112:127]
    v_cvt_pk_bf16_f32 v68, v104, v105
    v_cvt_pk_bf16_f32 v69, v106, v107
    v_cvt_pk_bf16_f32 v70, v108, v109
    v_cvt_pk_bf16_f32 v71, v110, v111
    buffer_store_dwordx4 v[68:71], v18, s[24:27], s81 offen offset:1024 sc1
    v_mfma_f32_32x32x16_bf16 v[112:127], v[60:63], v[236:239], v[112:127]
    s_nop 11
    v_cvt_pk_bf16_f32 v72, v112, v113
    v_cvt_pk_bf16_f32 v73, v114, v115
    v_cvt_pk_bf16_f32 v74, v116, v117
    v_cvt_pk_bf16_f32 v75, v118, v119
    buffer_store_dwordx4 v[72:75], v18, s[24:27], s81 offen offset:2048 sc1
    v_cvt_pk_bf16_f32 v76, v120, v121
    v_cvt_pk_bf16_f32 v77, v122, v123
    v_cvt_pk_bf16_f32 v78, v124, v125
    v_cvt_pk_bf16_f32 v79, v126, v127
    buffer_store_dwordx4 v[76:79], v18, s[24:27], s81 offen offset:3072 sc1
    s_branch L_B_stored
    s_nop 0
L_B_V:
    s_lshl_b32 s39, s44, 10
    s_add_u32 s81, s52, s39
    s_add_u32 s81, s81, 2097152
    s_waitcnt vmcnt(4)
    s_barrier
    ds_read_b128 v[128:131], v12 offset:0
    ds_read_b128 v[132:135], v13 offset:0
    ds_read_b128 v[136:139], v14 offset:0
    ds_read_b128 v[140:143], v15 offset:0
    ds_read_b64_tr_b16 v[64:65], v16 offset:0
    ds_read_b64_tr_b16 v[66:67], v16 offset:512
    ds_read_b64_tr_b16 v[68:69], v17 offset:0
    ds_read_b64_tr_b16 v[70:71], v17 offset:512
    ds_read_b64_tr_b16 v[72:73], v16 offset:2048
    ds_read_b64_tr_b16 v[74:75], v16 offset:2560
    ds_read_b64_tr_b16 v[76:77], v17 offset:2048
    ds_read_b64_tr_b16 v[78:79], v17 offset:2560
    s_waitcnt lgkmcnt(4)
    v_mfma_f32_32x32x16_bf16 v[96:111], v[128:131], v[64:67], 0
    ds_read_b64_tr_b16 v[80:81], v16 offset:4096
    ds_read_b64_tr_b16 v[82:83], v16 offset:4608
    ds_read_b64_tr_b16 v[84:85], v17 offset:4096
    ds_read_b64_tr_b16 v[86:87], v17 offset:4608
    v_mfma_f32_32x32x16_bf16 v[112:127], v[128:131], v[68:71], 0
    s_waitcnt lgkmcnt(4)
    v_mfma_f32_32x32x16_bf16 v[96:111], v[132:135], v[72:75], v[96:111]
    ds_read_b64_tr_b16 v[64:65], v16 offset:6144
    ds_read_b64_tr_b16 v[66:67], v16 offset:6656
    ds_read_b64_tr_b16 v[68:69], v17 offset:6144
    ds_read_b64_tr_b16 v[70:71], v17 offset:6656
    v_mfma_f32_32x32x16_bf16 v[112:127], v[132:135], v[76:79], v[112:127]
    s_waitcnt lgkmcnt(4)
    v_mfma_f32_32x32x16_bf16 v[96:111], v[136:139], v[80:83], v[96:111]
    s_waitcnt vmcnt(0)
    s_barrier
    ds_read_b128 v[144:147], v12 offset:16384
    ds_read_b128 v[148:151], v13 offset:16384
    ds_read_b128 v[152:155], v14 offset:16384
    ds_read_b128 v[156:159], v15 offset:16384
    ds_read_b64_tr_b16 v[72:73], v16 offset:8192
    ds_read_b64_tr_b16 v[74:75], v16 offset:8704
    ds_read_b64_tr_b16 v[76:77], v17 offset:8192
    ds_read_b64_tr_b16 v[78:79], v17 offset:8704
    v_mfma_f32_32x32x16_bf16 v[112:127], v[136:139], v[84:87], v[112:127]
    s_waitcnt lgkmcnt(8)
    v_mfma_f32_32x32x16_bf16 v[96:111], v[140:143], v[64:67], v[96:111]
    ds_read_b64_tr_b16 v[80:81], v16 offset:10240
    ds_read_b64_tr_b16 v[82:83], v16 offset:10752
    ds_read_b64_tr_b16 v[84:85], v17 offset:10240
    ds_read_b64_tr_b16 v[86:87], v17 offset:10752
    v_mfma_f32_32x32x16_bf16 v[112:127], v[140:143], v[68:71], v[112:127]
    s_waitcnt lgkmcnt(4)
    v_mfma_f32_32x32x16_bf16 v[96:111], v[144:147], v[72:75], v[96:111]
    ds_read_b64_tr_b16 v[64:65], v16 offset:12288
    ds_read_b64_tr_b16 v[66:67], v16 offset:12800
    ds_read_b64_tr_b16 v[68:69], v17 offset:12288
    ds_read_b64_tr_b16 v[70:71], v17 offset:12800
    v_mfma_f32_32x32x16_bf16 v[112:127], v[144:147], v[76:79], v[112:127]
    s_waitcnt lgkmcnt(4)
    v_mfma_f32_32x32x16_bf16 v[96:111], v[148:151], v[80:83], v[96:111]
    ds_read_b64_tr_b16 v[72:73], v16 offset:14336
    ds_read_b64_tr_b16 v[74:75], v16 offset:14848
    ds_read_b64_tr_b16 v[76:77], v17 offset:14336
    ds_read_b64_tr_b16 v[78:79], v17 offset:14848
    v_mfma_f32_32x32x16_bf16 v[112:127], v[148:151], v[84:87], v[112:127]
    s_waitcnt lgkmcnt(4)
    v_mfma_f32_32x32x16_bf16 v[96:111], v[152:155], v[64:67], v[96:111]
    s_barrier
    ds_read_b128 v[160:163], v12 offset:32768
    ds_read_b128 v[164:167], v13 offset:32768
    ds_read_b128 v[168:171], v14 offset:32768
    ds_read_b128 v[172:175], v15 offset:32768
    ds_read_b64_tr_b16 v[80:81], v16 offset:16384
    ds_read_b64_tr_b16 v[82:83], v16 offset:16896
    ds_read_b64_tr_b16 v[84:85], v17 offset:16384
    ds_read_b64_tr_b16 v[86:87], v17 offset:16896
    v_mfma_f32_32x32x16_bf16 v[112:127], v[152:155], v[68:71], v[112:127]
    s_waitcnt lgkmcnt(8)
    v_mfma_f32_32x32x16_bf16 v[96:111], v[156:159], v[72:75], v[96:111]
    ds_read_b64_tr_b16 v[64:65], v16 offset:18432
    ds_read_b64_tr_b16 v[66:67], v16 offset:18944
    ds_read_b64_tr_b16 v[68:69], v17 offset:18432
    ds_read_b64_tr_b16 v[70:71], v17 offset:18944
    v_mfma_f32_32x32x16_bf16 v[112:127], v[156:159], v[76:79], v[112:127]
    s_waitcnt lgkmcnt(4)
    v_mfma_f32_32x32x16_bf16 v[96:111], v[160:163], v[80:83], v[96:111]
    ds_read_b64_tr_b16 v[72:73], v16 offset:20480
    ds_read_b64_tr_b16 v[74:75], v16 offset:20992
    ds_read_b64_tr_b16 v[76:77], v17 offset:20480
    ds_read_b64_tr_b16 v[78:79], v17 offset:20992
    v_mfma_f32_32x32x16_bf16 v[112:127], v[160:163], v[84:87], v[112:127]
    s_waitcnt lgkmcnt(4)
    v_mfma_f32_32x32x16_bf16 v[96:111], v[164:167], v[64:67], v[96:111]
    ds_read_b64_tr_b16 v[80:81], v16 offset:22528
    ds_read_b64_tr_b16 v[82:83], v16 offset:23040
    ds_read_b64_tr_b16 v[84:85], v17 offset:22528
    ds_read_b64_tr_b16 v[86:87], v17 offset:23040
    v_mfma_f32_32x32x16_bf16 v[112:127], v[164:167], v[68:71], v[112:127]
    s_waitcnt lgkmcnt(4)
    v_mfma_f32_32x32x16_bf16 v[96:111], v[168:171], v[72:75], v[96:111]
    s_barrier
    v_add_u32 v8, 49152, v12
    v_add_u32 v9, 49152, v13
    v_add_u32 v10, 49152, v14
    v_add_u32 v11, 49152, v15
    ds_read_b128 v[176:179], v8 offset:0
    ds_read_b128 v[180:183], v9 offset:0
    ds_read_b128 v[184:187], v10 offset:0
    ds_read_b128 v[188:191], v11 offset:0
    ds_read_b64_tr_b16 v[64:65], v16 offset:24576
    ds_read_b64_tr_b16 v[66:67], v16 offset:25088
    ds_read_b64_tr_b16 v[68:69], v17 offset:24576
    ds_read_b64_tr_b16 v[70:71], v17 offset:25088
    v_mfma_f32_32x32x16_bf16 v[112:127], v[168:171], v[76:79], v[112:127]
    s_waitcnt lgkmcnt(8)
    v_mfma_f32_32x32x16_bf16 v[96:111], v[172:175], v[80:83], v[96:111]
    ds_read_b64_tr_b16 v[72:73], v16 offset:26624
    ds_read_b64_tr_b16 v[74:75], v16 offset:27136
    ds_read_b64_tr_b16 v[76:77], v17 offset:26624
    ds_read_b64_tr_b16 v[78:79], v17 offset:27136
    v_mfma_f32_32x32x16_bf16 v[112:127], v[172:175], v[84:87], v[112:127]
    s_waitcnt lgkmcnt(4)
    v_mfma_f32_32x32x16_bf16 v[96:111], v[176:179], v[64:67], v[96:111]
    ds_read_b64_tr_b16 v[80:81], v16 offset:28672
    ds_read_b64_tr_b16 v[82:83], v16 offset:29184
    ds_read_b64_tr_b16 v[84:85], v17 offset:28672
    ds_read_b64_tr_b16 v[86:87], v17 offset:29184
    v_mfma_f32_32x32x16_bf16 v[112:127], v[176:179], v[68:71], v[112:127]
    s_waitcnt lgkmcnt(4)
    v_mfma_f32_32x32x16_bf16 v[96:111], v[180:183], v[72:75], v[96:111]
    ds_read_b64_tr_b16 v[64:65], v16 offset:30720
    ds_read_b64_tr_b16 v[66:67], v16 offset:31232
    ds_read_b64_tr_b16 v[68:69], v17 offset:30720
    ds_read_b64_tr_b16 v[70:71], v17 offset:31232
    v_mfma_f32_32x32x16_bf16 v[112:127], v[180:183], v[76:79], v[112:127]
    s_waitcnt lgkmcnt(4)
    v_mfma_f32_32x32x16_bf16 v[96:111], v[184:187], v[80:83], v[96:111]
    s_barrier
    ds_read_b128 v[192:195], v8 offset:16384
    ds_read_b128 v[196:199], v9 offset:16384
    ds_read_b128 v[200:203], v10 offset:16384
    ds_read_b128 v[204:207], v11 offset:16384
    ds_read_b64_tr_b16 v[72:73], v16 offset:32768
    ds_read_b64_tr_b16 v[74:75], v16 offset:33280
    ds_read_b64_tr_b16 v[76:77], v17 offset:32768
    ds_read_b64_tr_b16 v[78:79], v17 offset:33280
    v_mfma_f32_32x32x16_bf16 v[112:127], v[184:187], v[84:87], v[112:127]
    s_waitcnt lgkmcnt(8)
    v_mfma_f32_32x32x16_bf16 v[96:111], v[188:191], v[64:67], v[96:111]
    ds_read_b64_tr_b16 v[80:81], v16 offset:34816
    ds_read_b64_tr_b16 v[82:83], v16 offset:35328
    ds_read_b64_tr_b16 v[84:85], v17 offset:34816
    ds_read_b64_tr_b16 v[86:87], v17 offset:35328
    v_mfma_f32_32x32x16_bf16 v[112:127], v[188:191], v[68:71], v[112:127]
    s_waitcnt lgkmcnt(4)
    v_mfma_f32_32x32x16_bf16 v[96:111], v[192:195], v[72:75], v[96:111]
    ds_read_b64_tr_b16 v[64:65], v16 offset:36864
    ds_read_b64_tr_b16 v[66:67], v16 offset:37376
    ds_read_b64_tr_b16 v[68:69], v17 offset:36864
    ds_read_b64_tr_b16 v[70:71], v17 offset:37376
    v_mfma_f32_32x32x16_bf16 v[112:127], v[192:195], v[76:79], v[112:127]
    s_waitcnt lgkmcnt(4)
    v_mfma_f32_32x32x16_bf16 v[96:111], v[196:199], v[80:83], v[96:111]
    ds_read_b64_tr_b16 v[72:73], v16 offset:38912
    ds_read_b64_tr_b16 v[74:75], v16 offset:39424
    ds_read_b64_tr_b16 v[76:77], v17 offset:38912
    ds_read_b64_tr_b16 v[78:79], v17 offset:39424
    v_mfma_f32_32x32x16_bf16 v[112:127], v[196:199], v[84:87], v[112:127]
    s_waitcnt lgkmcnt(4)
    v_mfma_f32_32x32x16_bf16 v[96:111], v[200:203], v[64:67], v[96:111]
    s_barrier
    global_load_dword v90, v24, s[22:23] offset:128 sc1
    ds_read_b128 v[208:211], v8 offset:32768
    ds_read_b128 v[212:215], v9 offset:32768
    ds_read_b128 v[216:219], v10 offset:32768
    ds_read_b128 v[220:223], v11 offset:32768
    ds_read_b64_tr_b16 v[80:81], v16 offset:40960
    ds_read_b64_tr_b16 v[82:83], v16 offset:41472
    ds_read_b64_tr_b16 v[84:85], v17 offset:40960
    ds_read_b64_tr_b16 v[86:87], v17 offset:41472
    v_mfma_f32_32x32x16_bf16 v[112:127], v[200:203], v[68:71], v[112:127]
    s_waitcnt lgkmcnt(8)
    v_mfma_f32_32x32x16_bf16 v[96:111], v[204:207], v[72:75], v[96:111]
    ds_read_b64_tr_b16 v[64:65], v16 offset:43008
    ds_read_b64_tr_b16 v[66:67], v16 offset:43520
    ds_read_b64_tr_b16 v[68:69], v17 offset:43008
    ds_read_b64_tr_b16 v[70:71], v17 offset:43520
    v_mfma_f32_32x32x16_bf16 v[112:127], v[204:207], v[76:79], v[112:127]
    s_waitcnt lgkmcnt(4)
    v_mfma_f32_32x32x16_bf16 v[96:111], v[208:211], v[80:83], v[96:111]
    ds_read_b64_tr_b16 v[72:73], v16 offset:45056
    ds_read_b64_tr_b16 v[74:75], v16 offset:45568
    ds_read_b64_tr_b16 v[76:77], v17 offset:45056
    ds_read_b64_tr_b16 v[78:79], v17 offset:45568
    v_mfma_f32_32x32x16_bf16 v[112:127], v[208:211], v[84:87], v[112:127]
    s_waitcnt lgkmcnt(4)
    v_mfma_f32_32x32x16_bf16 v[96:111], v[212:215], v[64:67], v[96:111]
    ds_read_b64_tr_b16 v[80:81], v16 offset:47104
    ds_read_b64_tr_b16 v[82:83], v16 offset:47616
    ds_read_b64_tr_b16 v[84:85], v17 offset:47104
    ds_read_b64_tr_b16 v[86:87], v17 offset:47616
    v_mfma_f32_32x32x16_bf16 v[112:127], v[212:215], v[68:71], v[112:127]
    s_waitcnt lgkmcnt(4)
    v_mfma_f32_32x32x16_bf16 v[96:111], v[216:219], v[72:75], v[96:111]
    ds_read_b64_tr_b16 v[32:33], v16 offset:49152
    ds_read_b64_tr_b16 v[34:35], v16 offset:49664
    ds_read_b64_tr_b16 v[36:37], v17 offset:49152
    ds_read_b64_tr_b16 v[38:39], v17 offset:49664
    v_mfma_f32_32x32x16_bf16 v[112:127], v[216:219], v[76:79], v[112:127]
    ds_read_b64_tr_b16 v[40:41], v16 offset:51200
    ds_read_b64_tr_b16 v[42:43], v16 offset:51712
    ds_read_b64_tr_b16 v[44:45], v17 offset:51200
    ds_read_b64_tr_b16 v[46:47], v17 offset:51712
    s_waitcnt lgkmcnt(8)
    v_mfma_f32_32x32x16_bf16 v[96:111], v[220:223], v[80:83], v[96:111]
    ds_read_b64_tr_b16 v[48:49], v16 offset:53248
    ds_read_b64_tr_b16 v[50:51], v16 offset:53760
    ds_read_b64_tr_b16 v[52:53], v17 offset:53248
    ds_read_b64_tr_b16 v[54:55], v17 offset:53760
    v_mfma_f32_32x32x16_bf16 v[112:127], v[220:223], v[84:87], v[112:127]
    s_waitcnt lgkmcnt(8)
    ds_read_b64_tr_b16 v[56:57], v16 offset:55296
    ds_read_b64_tr_b16 v[58:59], v16 offset:55808
    ds_read_b64_tr_b16 v[60:61], v17 offset:55296
    ds_read_b64_tr_b16 v[62:63], v17 offset:55808
    s_waitcnt lgkmcnt(8)
    s_barrier
    ds_read_b128 v[224:227], v12
    ds_read_b128 v[228:231], v13
    ds_read_b128 v[232:235], v14
    ds_read_b128 v[236:239], v15
    s_waitcnt lgkmcnt(3)
    v_mfma_f32_32x32x16_bf16 v[96:111], v[224:227], v[32:35], v[96:111]
    s_waitcnt lgkmcnt(2)
    v_mfma_f32_32x32x16_bf16 v[96:111], v[228:231], v[40:43], v[96:111]
    s_waitcnt lgkmcnt(1)
    v_mfma_f32_32x32x16_bf16 v[96:111], v[232:235], v[48:51], v[96:111]
    s_waitcnt lgkmcnt(0)
    v_mfma_f32_32x32x16_bf16 v[96:111], v[236:239], v[56:59], v[96:111]
    v_mfma_f32_32x32x16_bf16 v[112:127], v[224:227], v[36:39], v[112:127]
    s_nop 5
    v_mfma_f32_32x32x16_bf16 v[112:127], v[228:231], v[44:47], v[112:127]
    s_nop 3
    v_cvt_pk_bf16_f32 v64, v96, v97
    v_cvt_pk_bf16_f32 v65, v98, v99
    v_cvt_pk_bf16_f32 v66, v100, v101
    v_cvt_pk_bf16_f32 v67, v102, v103
    buffer_store_dwordx4 v[64:67], v6, s[24:27], s81 offen offset:0 sc1
    v_mfma_f32_32x32x16_bf16 v[112:127], v[232:235], v[52:55], v[112:127]
    v_cvt_pk_bf16_f32 v68, v104, v105
    v_cvt_pk_bf16_f32 v69, v106, v107
    v_cvt_pk_bf16_f32 v70, v108, v109
    v_cvt_pk_bf16_f32 v71, v110, v111
    buffer_store_dwordx4 v[68:71], v5, s[24:27], s81 offen offset:1024 sc1
    v_mfma_f32_32x32x16_bf16 v[112:127], v[236:239], v[60:63], v[112:127]
    s_nop 11
    v_cvt_pk_bf16_f32 v72, v112, v113
    v_cvt_pk_bf16_f32 v73, v114, v115
    v_cvt_pk_bf16_f32 v74, v116, v117
    v_cvt_pk_bf16_f32 v75, v118, v119
    buffer_store_dwordx4 v[72:75], v6, s[24:27], s81 offen offset:512 sc1
    v_cvt_pk_bf16_f32 v76, v120, v121
    v_cvt_pk_bf16_f32 v77, v122, v123
    v_cvt_pk_bf16_f32 v78, v124, v125
    v_cvt_pk_bf16_f32 v79, v126, v127
    buffer_store_dwordx4 v[76:79], v5, s[24:27], s81 offen offset:1536 sc1
L_B_stored:
    s_mov_b64 s[48:49], s[100:101]
    s_mov_b32 s50, 1204224
    s_bitcmp1_b32 0x2a54, s35
    s_cbranch_scc1 L_B_wqS
    s_add_u32 m0, s82, 131072
    s_bfe_u32 s39, s1, 0x30000
    s_mul_i32 s39, s39, 172032
    s_add_u32 s39, s39, s34
    buffer_load_dwordx4 v89, s[48:51], s39 offen lds
    s_add_u32 m0, s82, 135168
    s_bfe_u32 s39, s1, 0x30004
    s_mul_i32 s39, s39, 172032
    s_add_u32 s39, s39, s34
    buffer_load_dwordx4 v89, s[48:51], s39 offen lds
L_B_wqS:
    s_add_u32 m0, s82, 139264
    s_bfe_u32 s39, s1, 0x30008
    s_mul_i32 s39, s39, 172032
    s_add_u32 s39, s39, s34
    buffer_load_dwordx4 v89, s[48:51], s39 offen lds
    s_add_u32 m0, s82, 143360
    s_bfe_u32 s39, s1, 0x3000c
    s_mul_i32 s39, s39, 172032
    s_add_u32 s39, s39, s34
    buffer_load_dwordx4 v89, s[48:51], s39 offen lds
    s_cmp_ge_u32 s33, 14
    s_cselect_b32 s40, 14, 0
    s_addc_u32 s74, s32, s32
    s_sub_u32 s75, s33, s40
    s_cmp_eq_u32 s74, 0
    s_cselect_b32 s40, 3, 2
    s_cselect_b32 s76, 1, 0
    s_lshl2_add_u32 s38, s74, s37
    s_mul_i32 s73, s38, 28672
    s_lshl_b32 s38, s75, 5
    s_sub_u32 s39, 417, s38
    v_mov_b32 v32, s38
    v_mov_b32 v33, s39
    s_mov_b32 vcc_lo, 0xff00ff00
    s_mov_b32 vcc_hi, vcc_lo
    v_cndmask_b32 v34, v32, v33, vcc
    v_and_b32_e64 v35, 7, v0
    v_lshl_add_u32 v35, v35, 2, v34
    v_lshrrev_b32_e64 v36, 4, v0
    v_mul_u32_u24 v36, 448, v36
    v_add_lshl_u32 v31, v35, v36, 2
    v_bfe_u32 v35, v0, 1, 1
    v_mad_u32_u24 v34, v35, 31, v34
    v_min_u32 v34, 447, v34
    v_lshrrev_b32 v35, 5, v34
    v_and_b32 v36, 1, v0
    v_lshl_add_u32 v35, v35, 1, v36
    v_cmp_gt_u32 vcc, 256, v34
    v_add_u32 v34, 512, v34
    v_mul_u32_u24 v34, 1366, v34
    v_lshrrev_b32 v34, 16, v34
    v_cndmask_b32 v34, v34, v35, vcc
    v_lshlrev_b32_e64 v34, 7, v34
    v_add_u32 v20, 1929216, v34
    s_add_u32 s74, s82, s74
    s_cmp_eq_u32 s37, 2
    s_cselect_b32 s74, 16, s74
    s_cselect_b32 s76, 2, s76
    s_cmp_ge_u32 s37, s40
    s_cselect_b32 s76, 3, s76
    v_lshlrev_b32 v32, 2, v23
    v_sub_u32 v32, v22, v32
    v_cmp_le_i32 s[4:5], 0, v32
    v_cmp_le_i32 s[6:7], 1, v32
    v_cmp_le_i32 s[8:9], 2, v32
    v_cmp_le_i32 s[10:11], 3, v32
    v_cmp_le_i32 s[12:13], 8, v32
    v_cmp_le_i32 s[14:15], 9, v32
    v_cmp_le_i32 s[16:17], 10, v32
    v_cmp_le_i32 s[18:19], 11, v32
    v_cmp_le_i32 s[56:57], 16, v32
    v_cmp_le_i32 s[58:59], 17, v32
    v_cmp_le_i32 s[60:61], 18, v32
    v_cmp_le_i32 s[62:63], 19, v32
    v_cmp_le_i32 s[64:65], 24, v32
    v_cmp_le_i32 s[66:67], 25, v32
    v_cmp_le_i32 s[68:69], 26, v32
    v_cmp_le_i32 s[70:71], 27, v32
    v_mov_b32 v33, 0xffff
    v_cndmask_b32 v240, 0, v33, s[4:5]
    v_cndmask_b32 v240, v240, -1, s[6:7]
    v_cndmask_b32 v241, 0, v33, s[8:9]
    v_cndmask_b32 v241, v241, -1, s[10:11]
    v_cndmask_b32 v242, 0, v33, s[12:13]
    v_cndmask_b32 v242, v242, -1, s[14:15]
    v_cndmask_b32 v243, 0, v33, s[16:17]
    v_cndmask_b32 v243, v243, -1, s[18:19]
    v_cndmask_b32 v244, 0, v33, s[56:57]
    v_cndmask_b32 v244, v244, -1, s[58:59]
    v_cndmask_b32 v245, 0, v33, s[60:61]
    v_cndmask_b32 v245, v245, -1, s[62:63]
    v_cndmask_b32 v246, 0, v33, s[64:65]
    v_cndmask_b32 v246, v246, -1, s[66:67]
    v_cndmask_b32 v247, 0, v33, s[68:69]
    v_cndmask_b32 v247, v247, -1, s[70:71]
    s_waitcnt vmcnt(4)
    s_bitcmp1_b32 0x2a54, s35
    s_cbranch_scc0 L_B_drained
    s_waitcnt vmcnt(2)
L_B_drained:
    v_cmp_le_u32 vcc, 1, v90
    s_nop 0
    s_cbranch_vccz L_B_gowait
L_B_go:
    s_mov_b32 exec_lo, s72
    s_mov_b32 exec_hi, 0
    buffer_atomic_add v26, v2, s[24:27], s77 offen sc1
    s_mov_b64 exec, -1
    ds_write_b32 v21, v26
    s_mov_b32 s42, 0x100000
spin_1:
    ds_read_b32 v27, v19 offset:0
    s_waitcnt lgkmcnt(0)
    v_cmp_gt_u32 vcc, 1, v27
    s_sub_u32 s42, s42, 1
    s_cbranch_vccz spinx_2
    s_cbranch_scc0 spin_1
spinx_2:
    s_add_u32 m0, s82, 147456
    s_bfe_u32 s39, s1, 0x30010
    s_mul_i32 s39, s39, 172032
    s_add_u32 s39, s39, s34
    buffer_load_dwordx4 v89, s[48:51], s39 offen lds
    s_add_u32 m0, s82, 151552
    s_bfe_u32 s39, s1, 0x30014
    s_mul_i32 s39, s39, 172032
    s_add_u32 s39, s39, s34
    buffer_load_dwordx4 v89, s[48:51], s39 offen lds
    s_add_u32 m0, s82, 155648
    s_bfe_u32 s39, s1, 0x30018
    s_mul_i32 s39, s39, 172032
    s_add_u32 s39, s39, s34
    buffer_load_dwordx4 v89, s[48:51], s39 offen lds
L_B_Q:
    s_mov_b32 exec_hi, 0xffff
    ds_write_b128 v3, v[92:95] offset:25024
    s_mov_b64 exec, -1
    v_mov_b32 v26, 3
    s_waitcnt vmcnt(4)
    ds_write_b32 v21, v25
    s_mov_b32 s42, 0x100000
spin_3:
    ds_read_b32 v27, v88 offset:0
    s_waitcnt lgkmcnt(0)
    v_cmp_gt_u32_e64 vcc, 2, v27
    s_sub_u32 s42, s42, 1
    s_cbranch_vccz spinx_4
    s_cbranch_scc0 spin_3
spinx_4:
    ds_read_b64_tr_b16 v[96:97], v7 offset:0
    ds_read_b64_tr_b16 v[98:99], v7 offset:256
    ds_read_b64_tr_b16 v[100:101], v7 offset:1024
    ds_read_b64_tr_b16 v[102:103], v7 offset:1280
    ds_read_b64_tr_b16 v[104:105], v7 offset:2048
    ds_read_b64_tr_b16 v[106:107], v7 offset:2304
    ds_read_b64_tr_b16 v[108:109], v7 offset:3072
    ds_read_b64_tr_b16 v[110:111], v7 offset:3328
    ds_read_b64_tr_b16 v[112:113], v7 offset:4096
    ds_read_b64_tr_b16 v[114:115], v7 offset:4352
    ds_read_b64_tr_b16 v[116:117], v7 offset:5120
    ds_read_b64_tr_b16 v[118:119], v7 offset:5376
    s_waitcnt lgkmcnt(10)
    v_mfma_f32_32x32x16_bf16 v[64:79], v[96:99], v[128:131], 0
    ds_read_b64_tr_b16 v[120:121], v7 offset:6144
    ds_read_b64_tr_b16 v[122:123], v7 offset:6400
    s_waitcnt lgkmcnt(10)
    v_mfma_f32_32x32x16_bf16 v[64:79], v[100:103], v[132:135], v[64:79]
    ds_read_b64_tr_b16 v[124:125], v7 offset:7168
    ds_read_b64_tr_b16 v[126:127], v7 offset:7424
    s_waitcnt lgkmcnt(10)
    v_mfma_f32_32x32x16_bf16 v[64:79], v[104:107], v[136:139], v[64:79]
    ds_read_b64_tr_b16 v[96:97], v7 offset:8192
    ds_read_b64_tr_b16 v[98:99], v7 offset:8448
    s_waitcnt lgkmcnt(10)
    v_mfma_f32_32x32x16_bf16 v[64:79], v[108:111], v[140:143], v[64:79]
    ds_read_b64_tr_b16 v[100:101], v7 offset:9216
    ds_read_b64_tr_b16 v[102:103], v7 offset:9472
    s_waitcnt lgkmcnt(10)
    v_mfma_f32_32x32x16_bf16 v[64:79], v[112:115], v[144:147], v[64:79]
    ds_read_b64_tr_b16 v[104:105], v7 offset:10240
    ds_read_b64_tr_b16 v[106:107], v7 offset:10496
    s_waitcnt lgkmcnt(10)
    v_mfma_f32_32x32x16_bf16 v[64:79], v[116:119], v[148:151], v[64:79]
    ds_read_b64_tr_b16 v[108:109], v7 offset:11264
    ds_read_b64_tr_b16 v[110:111], v7 offset:11520
    s_waitcnt vmcnt(0)
    ds_write_b32 v21, v26
    s_waitcnt lgkmcnt(11)
    v_mfma_f32_32x32x16_bf16 v[64:79], v[120:123], v[152:155], v[64:79]
    ds_read_b64_tr_b16 v[112:113], v7 offset:12288
    ds_read_b64_tr_b16 v[114:115], v7 offset:12544
    s_waitcnt lgkmcnt(11)
    v_mfma_f32_32x32x16_bf16 v[64:79], v[124:127], v[156:159], v[64:79]
    ds_read_b64_tr_b16 v[116:117], v7 offset:13312
    ds_read_b64_tr_b16 v[118:119], v7 offset:13568
    ds_read_b32 v27, v19
    s_waitcnt lgkmcnt(12)
    v_mfma_f32_32x32x16_bf16 v[64:79], v[96:99], v[160:163], v[64:79]
    ds_read_b64_tr_b16 v[120:121], v7 offset:14336
    ds_read_b64_tr_b16 v[122:123], v7 offset:14592
    s_waitcnt lgkmcnt(12)
    v_mfma_f32_32x32x16_bf16 v[64:79], v[100:103], v[164:167], v[64:79]
    ds_read_b64_tr_b16 v[124:125], v7 offset:15360
    ds_read_b64_tr_b16 v[126:127], v7 offset:15616
    s_waitcnt lgkmcnt(12)
    v_mfma_f32_32x32x16_bf16 v[64:79], v[104:107], v[168:171], v[64:79]
    s_waitcnt lgkmcnt(4)
    v_cmp_gt_u32 vcc, 3, v27
    s_nop 0
    s_cbranch_vccnz L_B_qwait
L_B_qok:
    ds_read_b64_tr_b16 v[96:97], v7 offset:16384
    ds_read_b64_tr_b16 v[98:99], v7 offset:16640
    v_mfma_f32_32x32x16_bf16 v[64:79], v[108:111], v[172:175], v[64:79]
    ds_read_b64_tr_b16 v[100:101], v7 offset:17408
    ds_read_b64_tr_b16 v[102:103], v7 offset:17664
    v_mfma_f32_32x32x16_bf16 v[64:79], v[112:115], v[176:179], v[64:79]
    ds_read_b64_tr_b16 v[104:105], v7 offset:18432
    ds_read_b64_tr_b16 v[106:107], v7 offset:18688
    v_mfma_f32_32x32x16_bf16 v[64:79], v[116:119], v[180:183], v[64:79]
    ds_read_b64_tr_b16 v[108:109], v7 offset:19456
    ds_read_b64_tr_b16 v[110:111], v7 offset:19712
    s_waitcnt lgkmcnt(10)
    v_mfma_f32_32x32x16_bf16 v[64:79], v[120:123], v[184:187], v[64:79]
    ds_read_b64_tr_b16 v[112:113], v7 offset:20480
    ds_read_b64_tr_b16 v[114:115], v7 offset:20736
    s_waitcnt lgkmcnt(10)
    v_mfma_f32_32x32x16_bf16 v[64:79], v[124:127], v[188:191], v[64:79]
    ds_read_b64_tr_b16 v[116:117], v7 offset:21504
    ds_read_b64_tr_b16 v[118:119], v7 offset:21760
    s_waitcnt lgkmcnt(10)
    v_mfma_f32_32x32x16_bf16 v[64:79], v[96:99], v[192:195], v[64:79]
    ds_read_b64_tr_b16 v[120:121], v7 offset:22528
    ds_read_b64_tr_b16 v[122:123], v7 offset:22784
    s_waitcnt lgkmcnt(10)
    v_mfma_f32_32x32x16_bf16 v[64:79], v[100:103], v[196:199], v[64:79]
    ds_read_b64_tr_b16 v[124:125], v7 offset:23552
    ds_read_b64_tr_b16 v[126:127], v7 offset:23808
    s_waitcnt lgkmcnt(10)
    v_mfma_f32_32x32x16_bf16 v[64:79], v[104:107], v[200:203], v[64:79]
    ds_read_b64_tr_b16 v[96:97], v7 offset:24576
    ds_read_b64_tr_b16 v[98:99], v7 offset:24832
    s_waitcnt lgkmcnt(10)
    v_mfma_f32_32x32x16_bf16 v[64:79], v[108:111], v[204:207], v[64:79]
    ds_read_b64_tr_b16 v[100:101], v7 offset:25600
    ds_read_b64_tr_b16 v[102:103], v7 offset:25856
    s_waitcnt lgkmcnt(10)
    v_mfma_f32_32x32x16_bf16 v[64:79], v[112:115], v[208:211], v[64:79]
    ds_read_b64_tr_b16 v[104:105], v7 offset:26624
    ds_read_b64_tr_b16 v[106:107], v7 offset:26880
    s_waitcnt lgkmcnt(10)
    v_mfma_f32_32x32x16_bf16 v[64:79], v[116:119], v[212:215], v[64:79]
    ds_read_b64_tr_b16 v[108:109], v7 offset:27648
    ds_read_b64_tr_b16 v[110:111], v7 offset:27904
    s_waitcnt lgkmcnt(10)
    v_mfma_f32_32x32x16_bf16 v[64:79], v[120:123], v[216:219], v[64:79]
    s_waitcnt lgkmcnt(8)
    v_mfma_f32_32x32x16_bf16 v[64:79], v[124:127], v[220:223], v[64:79]
    s_waitcnt lgkmcnt(6)
    v_mfma_f32_32x32x16_bf16 v[64:79], v[96:99], v[224:227], v[64:79]
    s_waitcnt lgkmcnt(4)
    v_mfma_f32_32x32x16_bf16 v[64:79], v[100:103], v[228:231], v[64:79]
    s_waitcnt lgkmcnt(2)
    v_mfma_f32_32x32x16_bf16 v[64:79], v[104:107], v[232:235], v[64:79]
    s_waitcnt lgkmcnt(0)
    v_mfma_f32_32x32x16_bf16 v[64:79], v[108:111], v[236:239], v[64:79]
    v_mov_b32_e64 v26, 4
    ds_write_b32 v21, v26
    s_mov_b32 s38, 0x3e8b97f6
    s_bitcmp1_b32 s35, 0
    s_cselect_b32 s40, 0, -1
    s_mov_b32 s41, -1
    s_mov_b32 s82, -1
    s_cselect_b32 s83, -1, 0
    s_nop 3
    v_pk_mul_f32 v[64:65], v[64:65], s[38:39] op_sel_hi:[1,0]
    v_pk_mul_f32 v[66:67], v[66:67], s[38:39] op_sel_hi:[1,0]
    v_pk_mul_f32 v[68:69], v[68:69], s[38:39] op_sel_hi:[1,0]
    v_pk_mul_f32 v[70:71], v[70:71], s[38:39] op_sel_hi:[1,0]
    v_pk_mul_f32 v[72:73], v[72:73], s[38:39] op_sel_hi:[1,0]
    v_pk_mul_f32 v[74:75], v[74:75], s[38:39] op_sel_hi:[1,0]
    v_pk_mul_f32 v[76:77], v[76:77], s[38:39] op_sel_hi:[1,0]
    v_pk_mul_f32 v[78:79], v[78:79], s[38:39] op_sel_hi:[1,0]
    v_cvt_pk_bf16_f32 v248, v64, v65
    v_cvt_pk_bf16_f32 v249, v66, v67
    v_cvt_pk_bf16_f32 v250, v68, v69
    v_cvt_pk_bf16_f32 v251, v70, v71
    v_cvt_pk_bf16_f32 v252, v72, v73
    v_cvt_pk_bf16_f32 v253, v74, v75
    v_cvt_pk_bf16_f32 v254, v76, v77
    v_cvt_pk_bf16_f32 v255, v78, v79
    v_cndmask_b32 v248, 0, v248, s[40:41]
    v_cndmask_b32 v249, 0, v249, s[40:41]
    v_cndmask_b32 v254, 0, v254, s[82:83]
    v_cndmask_b32 v255, 0, v255, s[82:83]
    s_lshl4_add_u32 s20, s54, s35
    s_lshr_b32 s21, s20, 2
    s_lshl_b32 s21, s21, 6
    s_lshr_b32 s20, s20, 2
    s_lshl_b32 s20, s20, 13
    s_and_b32 s38, s35, 3
    s_lshl_b32 s38, s38, 8
    s_add_u32 s20, s20, 5775360
    s_add_u32 s53, s20, s38
    s_add_u32 s53, s53, 5888
    s_lshl1_add_u32 s52, s38, s20
    s_add_u32 s52, s52, 4096
    s_lshl2_add_u32 s20, s38, s20
    v_lshrrev_b32 v6, 1, v18
L_B_att:
    s_mov_b32 s42, 0x100000
    s_waitcnt lgkmcnt(0)
spin_5:
    ds_read_b32 v27, v19 offset:16
    ds_read_b128 v[96:99], v4 offset:16384
    ds_read_b128 v[100:103], v4 offset:17408
    ds_read_b128 v[104:107], v4 offset:0
    ds_read_b128 v[108:111], v4 offset:1024
    s_waitcnt lgkmcnt(4)
    v_cmp_gt_u32 vcc, 2, v27
    s_sub_u32 s42, s42, 1
    s_cbranch_vccz spinx_6
    s_cbranch_scc0 spin_5
spinx_6:
    s_waitcnt lgkmcnt(2)
    v_mfma_f32_32x32x16_bf16 v[64:79], v[96:99], v[248:251], 0
    ds_read_b128 v[32:35], v4 offset:14336
    ds_read_b128 v[36:39], v4 offset:15360
    ds_read_b128 v[40:43], v4 offset:12288
    ds_read_b128 v[44:47], v4 offset:13312
    ds_read_b128 v[48:51], v4 offset:10240
    ds_read_b128 v[52:55], v4 offset:11264
    v_mfma_f32_32x32x16_bf16 v[64:79], v[100:103], v[252:255], v[64:79]
    ds_read_b128 v[56:59], v4 offset:8192
    ds_read_b128 v[60:63], v4 offset:9216
    ds_read_b128 v[160:163], v4 offset:6144
    ds_read_b128 v[164:167], v4 offset:7168
    s_waitcnt lgkmcnt(10)
    v_mfma_f32_32x32x16_bf16 v[80:95], v[104:107], v[248:251], 0
    ds_read_b128 v[168:171], v4 offset:4096
    ds_read_b128 v[172:175], v4 offset:5120
    s_cmp_ge_u32 s54, 8
    v_mfma_f32_32x32x16_bf16 v[80:95], v[108:111], v[252:255], v[80:95]
    ds_read_b128 v[176:179], v4 offset:2048
    ds_read_b128 v[180:183], v4 offset:3072
    s_cbranch_scc0 L_B_noold
L_B_merge:
    s_nop 8
    v_cndmask_b32 v64, v80, v64, s[4:5]
    v_cndmask_b32 v65, v81, v65, s[6:7]
    v_cndmask_b32 v66, v82, v66, s[8:9]
    v_cndmask_b32 v67, v83, v67, s[10:11]
    v_cndmask_b32 v68, v84, v68, s[12:13]
    v_cndmask_b32 v69, v85, v69, s[14:15]
    v_cndmask_b32 v70, v86, v70, s[16:17]
    v_cndmask_b32 v71, v87, v71, s[18:19]
    v_cndmask_b32 v72, v88, v72, s[56:57]
    v_cndmask_b32 v73, v89, v73, s[58:59]
    v_cndmask_b32 v74, v90, v74, s[60:61]
    v_cndmask_b32 v75, v91, v75, s[62:63]
    ds_read_b32 v27, v19 offset:16
    v_cndmask_b32 v76, v92, v76, s[64:65]
    v_cndmask_b32 v77, v93, v77, s[66:67]
    v_cndmask_b32 v78, v94, v78, s[68:69]
    v_cndmask_b32 v79, v95, v79, s[70:71]
    v_max3_f32 v8, v64, v65, v66
    v_max3_f32 v9, v67, v68, v69
    v_max3_f32 v8, v8, v70, v71
    v_max3_f32 v9, v9, v72, v73
    v_max3_f32 v8, v8, v74, v75
    v_max3_f32 v9, v9, v76, v77
    v_max3_f32 v8, v8, v78, v79
    v_max_f32_e64 v10, v8, v9
    v_max_f32 v11, v8, v9
    s_waitcnt lgkmcnt(0)
    v_cmp_gt_u32 vcc, 3, v27
    v_permlane32_swap_b32 v10, v11
    v_min_f32 v112, -v10, -v11
    v_min_f32 v113, -v10, -v11
    s_cbranch_vccnz L_B_vwait
L_B_vok:
    v_mov_b64 v[114:115], v[112:113]
    v_mov_b64 v[116:117], v[112:113]
    v_mov_b64 v[118:119], v[112:113]
    v_mov_b64 v[120:121], v[112:113]
    v_mov_b64 v[122:123], v[112:113]
    v_mov_b64 v[124:125], v[112:113]
    v_mov_b64 v[126:127], v[112:113]
    ds_read_b128 v[184:187], v4 offset:40960
    ds_read_b128 v[188:191], v4 offset:41984
    v_mfma_f32_32x32x16_bf16 v[80:95], v[32:35], v[248:251], v[112:127]
    v_pk_add_f32 v[64:65], v[64:65], v[112:113]
    v_pk_add_f32 v[66:67], v[66:67], v[112:113]
    v_pk_add_f32 v[68:69], v[68:69], v[112:113]
    v_pk_add_f32 v[70:71], v[70:71], v[112:113]
    v_pk_add_f32 v[72:73], v[72:73], v[112:113]
    v_pk_add_f32 v[74:75], v[74:75], v[112:113]
    v_mfma_f32_32x32x16_bf16 v[80:95], v[36:39], v[252:255], v[80:95]
    v_pk_add_f32 v[76:77], v[76:77], v[112:113]
    v_pk_add_f32 v[78:79], v[78:79], v[112:113]
    ds_read_b128 v[192:195], v4 offset:24576
    v_exp_f32_e64 v64, v64
    ds_read_b128 v[196:199], v4 offset:25600
    v_exp_f32_e64 v65, v65
    ds_read_b128 v[200:203], v4 offset:38912
    v_exp_f32_e64 v66, v66
    ds_read_b128 v[204:207], v4 offset:39936
    v_exp_f32_e64 v67, v67
    ds_read_b128 v[208:211], v4 offset:36864
    v_exp_f32_e64 v68, v68
    ds_read_b128 v[212:215], v4 offset:37888
    v_exp_f32_e64 v69, v69
    ds_read_b128 v[216:219], v4 offset:34816
    v_exp_f32_e64 v70, v70
    ds_read_b128 v[220:223], v4 offset:35840
    v_exp_f32_e64 v71, v71
    ds_read_b128 v[224:227], v4 offset:32768
    v_exp_f32_e64 v72, v72
    v_cvt_pk_bf16_f32 v152, v64, v65
    ds_read_b128 v[228:231], v4 offset:33792
    v_exp_f32_e64 v73, v73
    v_cvt_pk_bf16_f32 v153, v66, v67
    ds_read_b128 v[232:235], v4 offset:30720
    v_exp_f32_e64 v74, v74
    v_cvt_pk_bf16_f32 v154, v68, v69
    ds_read_b128 v[236:239], v4 offset:31744
    v_exp_f32_e64 v75, v75
    v_cvt_pk_bf16_f32 v155, v70, v71
    v_and_b32 v144, v240, v152
    v_and_b32 v145, v241, v153
    v_and_b32 v146, v242, v154
    v_and_b32 v147, v243, v155
    v_exp_f32_e64 v76, v76
    v_exp_f32 v77, v77
    s_waitcnt lgkmcnt(8)
    v_mfma_f32_32x32x16_bf16 v[128:143], v[184:187], v[144:147], 0
    v_exp_f32 v78, v78
    v_exp_f32 v79, v79
    v_xor_b32 v152, v144, v152
    v_xor_b32 v153, v145, v153
    v_xor_b32 v154, v146, v154
    v_xor_b32 v155, v147, v155
    v_cvt_pk_bf16_f32 v156, v72, v73
    v_cvt_pk_bf16_f32 v157, v74, v75
    v_mfma_f32_32x32x16_bf16 v[128:143], v[192:195], v[152:155], v[128:143]
    v_cvt_pk_bf16_f32 v158, v76, v77
    v_cvt_pk_bf16_f32 v159, v78, v79
    v_and_b32 v148, v244, v156
    v_and_b32 v149, v245, v157
    v_and_b32 v150, v246, v158
    v_and_b32 v151, v247, v159
    v_xor_b32 v156, v148, v156
    v_xor_b32 v157, v149, v157
    v_mfma_f32_32x32x16_bf16 v[128:143], v[188:191], v[148:151], v[128:143]
    v_xor_b32 v158, v150, v158
    v_xor_b32 v159, v151, v159
    v_exp_f32 v80, v80
    v_exp_f32 v81, v81
    v_mfma_f32_32x32x16_bf16 v[128:143], v[196:199], v[156:159], v[128:143]
    v_exp_f32 v82, v82
    v_exp_f32 v83, v83
    v_exp_f32 v84, v84
    v_exp_f32 v85, v85
    v_mfma_f32_32x32x16_bf16 v[96:111], v[40:43], v[248:251], v[112:127]
    v_exp_f32 v86, v86
    v_exp_f32 v87, v87
    v_cvt_pk_bf16_f32 v144, v80, v81
    v_cvt_pk_bf16_f32 v145, v82, v83
    v_cvt_pk_bf16_f32 v146, v84, v85
    v_cvt_pk_bf16_f32 v147, v86, v87
    v_mfma_f32_32x32x16_bf16 v[96:111], v[44:47], v[252:255], v[96:111]
    v_exp_f32 v88, v88
    v_exp_f32 v89, v89
    ds_read_b128 v[32:35], v4 offset:28672
    ds_read_b128 v[36:39], v4 offset:29696
    ds_read_b128 v[40:43], v4 offset:26624
    ds_read_b128 v[44:47], v4 offset:27648
    v_exp_f32 v90, v90
    v_exp_f32 v91, v91
    v_mfma_f32_32x32x16_bf16 v[128:143], v[200:203], v[144:147], v[128:143]
    v_exp_f32 v92, v92
    v_exp_f32 v93, v93
    v_exp_f32 v94, v94
    v_exp_f32 v95, v95
    v_cvt_pk_bf16_f32 v148, v88, v89
    v_cvt_pk_bf16_f32 v149, v90, v91
    v_cvt_pk_bf16_f32 v150, v92, v93
    v_cvt_pk_bf16_f32 v151, v94, v95
    v_exp_f32 v96, v96
    v_exp_f32 v97, v97
    v_mfma_f32_32x32x16_bf16 v[128:143], v[204:207], v[148:151], v[128:143]
    v_exp_f32 v98, v98
    v_exp_f32 v99, v99
    v_exp_f32 v100, v100
    v_exp_f32 v101, v101
    v_mfma_f32_32x32x16_bf16 v[80:95], v[48:51], v[248:251], v[112:127]
    v_exp_f32 v102, v102
    v_exp_f32 v103, v103
    v_cvt_pk_bf16_f32 v152, v96, v97
    v_cvt_pk_bf16_f32 v153, v98, v99
    v_cvt_pk_bf16_f32 v154, v100, v101
    v_cvt_pk_bf16_f32 v155, v102, v103
    v_mfma_f32_32x32x16_bf16 v[80:95], v[52:55], v[252:255], v[80:95]
    v_exp_f32 v104, v104
    v_exp_f32 v105, v105
    v_exp_f32_e64 v106, v106
    v_exp_f32 v107, v107
    s_waitcnt lgkmcnt(0)
    v_mfma_f32_32x32x16_bf16 v[128:143], v[208:211], v[152:155], v[128:143]
    v_exp_f32 v108, v108
    v_exp_f32 v109, v109
    v_exp_f32 v110, v110
    v_exp_f32 v111, v111
    v_cvt_pk_bf16_f32 v156, v104, v105
    v_cvt_pk_bf16_f32 v157, v106, v107
    v_cvt_pk_bf16_f32 v158, v108, v109
    v_cvt_pk_bf16_f32 v159, v110, v111
    v_exp_f32 v80, v80
    v_exp_f32 v81, v81
    v_mfma_f32_32x32x16_bf16 v[128:143], v[212:215], v[156:159], v[128:143]
    v_exp_f32 v82, v82
    v_exp_f32 v83, v83
    v_exp_f32 v84, v84
    v_exp_f32 v85, v85
    v_mfma_f32_32x32x16_bf16 v[96:111], v[56:59], v[248:251], v[112:127]
    v_exp_f32 v86, v86
    v_exp_f32 v87, v87
    v_cvt_pk_bf16_f32 v144, v80, v81
    v_cvt_pk_bf16_f32 v145, v82, v83
    v_cvt_pk_bf16_f32 v146, v84, v85
    v_cvt_pk_bf16_f32 v147, v86, v87
    v_mfma_f32_32x32x16_bf16 v[96:111], v[60:63], v[252:255], v[96:111]
    v_exp_f32 v88, v88
    v_exp_f32 v89, v89
    v_exp_f32 v90, v90
    v_exp_f32 v91, v91
    v_mfma_f32_32x32x16_bf16 v[128:143], v[216:219], v[144:147], v[128:143]
    v_exp_f32 v92, v92
    v_exp_f32 v93, v93
    v_exp_f32 v94, v94
    v_exp_f32 v95, v95
    v_cvt_pk_bf16_f32 v148, v88, v89
    v_cvt_pk_bf16_f32 v149, v90, v91
    v_cvt_pk_bf16_f32 v150, v92, v93
    v_cvt_pk_bf16_f32 v151, v94, v95
    v_exp_f32 v96, v96
    v_exp_f32 v97, v97
    v_mfma_f32_32x32x16_bf16 v[128:143], v[220:223], v[148:151], v[128:143]
    v_exp_f32 v98, v98
    v_exp_f32 v99, v99
    v_exp_f32 v100, v100
    v_exp_f32 v101, v101
    v_mfma_f32_32x32x16_bf16 v[80:95], v[160:163], v[248:251], v[112:127]
    v_exp_f32 v102, v102
    v_exp_f32 v103, v103
    v_cvt_pk_bf16_f32 v152, v96, v97
    v_cvt_pk_bf16_f32 v153, v98, v99
    v_cvt_pk_bf16_f32 v154, v100, v101
    v_cvt_pk_bf16_f32 v155, v102, v103
    v_mfma_f32_32x32x16_bf16 v[80:95], v[164:167], v[252:255], v[80:95]
    v_exp_f32 v104, v104
    v_exp_f32 v105, v105
    v_exp_f32 v106, v106
    v_exp_f32 v107, v107
    v_mfma_f32_32x32x16_bf16 v[128:143], v[224:227], v[152:155], v[128:143]
    v_exp_f32 v108, v108
    v_exp_f32 v109, v109
    v_exp_f32 v110, v110
    v_exp_f32 v111, v111
    v_cvt_pk_bf16_f32 v156, v104, v105
    v_cvt_pk_bf16_f32 v157, v106, v107
    v_cvt_pk_bf16_f32 v158, v108, v109
    v_cvt_pk_bf16_f32 v159, v110, v111
    v_exp_f32 v80, v80
    v_exp_f32 v81, v81
    v_mfma_f32_32x32x16_bf16 v[128:143], v[228:231], v[156:159], v[128:143]
    v_exp_f32 v82, v82
    v_exp_f32 v83, v83
    v_exp_f32 v84, v84
    v_exp_f32 v85, v85
    v_mfma_f32_32x32x16_bf16 v[96:111], v[168:171], v[248:251], v[112:127]
    v_exp_f32 v86, v86
    v_exp_f32 v87, v87
    v_cvt_pk_bf16_f32 v144, v80, v81
    v_cvt_pk_bf16_f32 v145, v82, v83
    v_cvt_pk_bf16_f32 v146, v84, v85
    v_cvt_pk_bf16_f32 v147, v86, v87
    v_mfma_f32_32x32x16_bf16 v[96:111], v[172:175], v[252:255], v[96:111]
    v_exp_f32 v88, v88
    v_exp_f32 v89, v89
    v_exp_f32 v90, v90
    v_exp_f32 v91, v91
    v_mfma_f32_32x32x16_bf16 v[128:143], v[232:235], v[144:147], v[128:143]
    v_exp_f32 v92, v92
    v_exp_f32 v93, v93
    v_exp_f32 v94, v94
    v_exp_f32 v95, v95
    v_cvt_pk_bf16_f32 v148, v88, v89
    v_cvt_pk_bf16_f32 v149, v90, v91
    v_cvt_pk_bf16_f32 v150, v92, v93
    v_cvt_pk_bf16_f32 v151, v94, v95
    v_exp_f32 v96, v96
    v_exp_f32 v97, v97
    v_mfma_f32_32x32x16_bf16 v[128:143], v[236:239], v[148:151], v[128:143]
    v_exp_f32 v98, v98
    v_exp_f32 v99, v99
    v_exp_f32 v100, v100
    v_exp_f32 v101, v101
    v_mfma_f32_32x32x16_bf16 v[80:95], v[176:179], v[248:251], v[112:127]
    v_exp_f32 v102, v102
    v_exp_f32 v103, v103
    v_cvt_pk_bf16_f32 v152, v96, v97
    v_cvt_pk_bf16_f32 v153, v98, v99
    v_cvt_pk_bf16_f32 v154, v100, v101
    v_cvt_pk_bf16_f32 v155, v102, v103
    v_mfma_f32_32x32x16_bf16 v[80:95], v[180:183], v[252:255], v[80:95]
    v_exp_f32 v104, v104
    v_exp_f32 v105, v105
    v_exp_f32 v106, v106
    v_exp_f32 v107, v107
    v_mfma_f32_32x32x16_bf16 v[128:143], v[32:35], v[152:155], v[128:143]
    v_exp_f32 v108, v108
    v_exp_f32 v109, v109
    v_exp_f32 v110, v110
    v_exp_f32 v111, v111
    v_cvt_pk_bf16_f32 v156, v104, v105
    v_cvt_pk_bf16_f32 v157, v106, v107
    v_cvt_pk_bf16_f32 v158, v108, v109
    v_cvt_pk_bf16_f32 v159, v110, v111
    v_exp_f32 v80, v80
    v_exp_f32 v81, v81
    v_mfma_f32_32x32x16_bf16 v[128:143], v[36:39], v[156:159], v[128:143]
    v_exp_f32 v82, v82
    v_exp_f32 v83, v83
    v_exp_f32 v84, v84
    v_exp_f32 v85, v85
    v_exp_f32 v86, v86
    v_exp_f32 v87, v87
    v_cvt_pk_bf16_f32 v144, v80, v81
    v_cvt_pk_bf16_f32 v145, v82, v83
    v_cvt_pk_bf16_f32 v146, v84, v85
    v_cvt_pk_bf16_f32 v147, v86, v87
    v_exp_f32 v88, v88
    v_exp_f32 v89, v89
    v_exp_f32 v90, v90
    v_exp_f32 v91, v91
    v_mfma_f32_32x32x16_bf16 v[128:143], v[40:43], v[144:147], v[128:143]
    v_exp_f32 v92, v92
    v_exp_f32 v93, v93
    v_exp_f32 v94, v94
    v_exp_f32 v95, v95
    v_cvt_pk_bf16_f32 v148, v88, v89
    v_cvt_pk_bf16_f32 v149, v90, v91
    v_cvt_pk_bf16_f32 v150, v92, v93
    v_cvt_pk_bf16_f32 v151, v94, v95
    buffer_load_dword v16, v20, s[24:27], 0 offen sc1
    ds_read_b32 v17, v19
    v_mfma_f32_32x32x16_bf16 v[128:143], v[44:47], v[148:151], v[128:143]
L_B_p2done:
    s_mov_b32 vcc_lo, -1
    s_mov_b32 vcc_hi, 0
    v_mov_b32 v10, 0x71800000
    v_mov_b32 v11, 0x207
    s_nop 7
    v_mov_b32 v8, v140
    v_mov_b32_e64 v9, v140
    s_nop 1
    v_permlane32_swap_b32 v8, v9
    v_rcp_f32 v8, v9
    s_nop 0
    v_pk_mul_f32 v[128:129], v[128:129], v[8:9] op_sel_hi:[1,0]
    v_pk_mul_f32 v[130:131], v[130:131], v[8:9] op_sel_hi:[1,0]
    v_pk_mul_f32 v[132:133], v[132:133], v[8:9] op_sel_hi:[1,0]
    v_pk_mul_f32 v[134:135], v[134:135], v[8:9] op_sel_hi:[1,0]
    v_cvt_pk_bf16_f32 v144, v128, v129
    v_cvt_pk_bf16_f32 v145, v130, v131
    v_cvt_pk_bf16_f32 v146, v132, v133
    v_cvt_pk_bf16_f32 v147, v134, v135
    buffer_store_dwordx4 v[144:147], v18, s[24:27], s20 offen offset:0 sc1
    v_pk_mul_f32 v[136:137], v[136:137], v[8:9] op_sel_hi:[1,0]
    v_pk_mul_f32 v[138:139], v[138:139], v[8:9] op_sel_hi:[1,0]
    v_pk_mul_f32 v[140:141], v[140:141], v[8:9] op_sel_hi:[1,0]
    v_pk_mul_f32 v[142:143], v[142:143], v[8:9] op_sel_hi:[1,0]
    v_cvt_pk_bf16_f32 v148, v136, v137
    v_cvt_pk_bf16_f32 v149, v138, v139
    v_cvt_pk_bf16_f32 v150, v140, v141
    v_cvt_pk_bf16_f32 v151, v142, v143
    s_mov_b32 exec_hi, 0
    buffer_store_dwordx4 v[148:151], v18, s[24:27], s52 offen sc1
    s_not_b64 exec, exec
    buffer_store_dwordx2 v[148:149], v6, s[24:27], s53 offen sc1
    s_mov_b64 exec, -1
    v_pk_add_f32 v[128:129], v[128:129], v[136:137]
    v_pk_add_f32 v[130:131], v[130:131], v[138:139]
    v_pk_add_f32 v[132:133], v[132:133], v[140:141]
    v_pk_add_f32 v[134:135], v[134:135], v[142:143]
    v_pk_add_f32 v[128:129], v[128:129], v[132:133]
    v_pk_add_f32 v[130:131], v[130:131], v[134:135]
    v_pk_add_f32 v[128:129], v[128:129], v[130:131]
    v_add_f32 v128, v128, v129
    v_cmp_nlt_f32_e64 vcc, v9, v10
    v_cmp_class_f32 s[82:83], v128, v11
    s_nop 0
    s_or_b64 vcc, vcc, s[82:83]
    s_cbranch_vccnz L_B_redo
L_B_accept:
    s_cmp_eq_u32 s43, 0
    s_cbranch_scc1 L_B_nog
    s_waitcnt lgkmcnt(0)
    v_cmp_gt_u32 s[82:83], 4, v17
    s_lshl_b32 s72, s37, 12
    v_mov_b32_e64 v25, 5
    s_waitcnt vmcnt(3)
    v_cmp_gt_u32 vcc, 1, v16
    s_nop 0
    s_or_b64 s[78:79], vcc, s[82:83]
    s_cbranch_scc1 L_B_gskip
    s_add_u32 m0, s72, 143360
    s_add_u32 s39, s73, 3936256
    buffer_load_dwordx4 v31, s[24:27], s39 offen sc1 lds
    s_add_u32 m0, s72, 144384
    s_add_u32 s39, s73, 3943424
    buffer_load_dwordx4 v31, s[24:27], s39 offen sc1 lds
    s_add_u32 m0, s72, 145408
    s_add_u32 s39, s73, 3950592
    buffer_load_dwordx4 v31, s[24:27], s39 offen sc1 lds
    s_add_u32 m0, s72, 146432
    s_add_u32 s39, s73, 3957760
    buffer_load_dwordx4 v31, s[24:27], s39 offen sc1 lds
L_B_gskip:
    s_waitcnt vmcnt(4)
    s_cmp_eq_u64 s[78:79], 0
    s_cbranch_scc1 of_7
    s_waitcnt vmcnt(0)
of_7:
    s_atomic_add s0, s[46:47], s21 offset:73728
    s_setprio 0
    s_cmp_eq_u32 s76, 3
    s_cbranch_scc1 L_B_notask
    v_lshlrev_b32 v8, 2, v22
    v_sub_u32 v9, 252, v8
    s_cmp_ge_u32 s75, 7
    s_cselect_b64 s[82:83], -1, 0
    v_cndmask_b32 v28, v8, v9, s[82:83]
    v_cndmask_b32 v29, v9, v8, s[82:83]
    v_lshlrev_b32_e64 v8, 10, v23
    v_add_u32 v8, 143360, v8
    v_add_u32 v28, v8, v28
    v_add_u32 v29, v8, v29
    v_lshrrev_b32_e64 v10, 2, v0
    v_lshl_add_u32 v1, v10, 5, s74
    v_sub_u32 v9, 2048, v1
    v_mul_u32_u24 v8, 1792, v1
    v_mul_u32_u24 v9, 1792, v9
    s_cmp_eq_u32 s76, 1
    s_cselect_b32 s40, 0x40000000, 0
    v_bfe_u32 v10, v0, 3, 2
    v_xor_b32_e64 v10, v10, v30
    v_lshl_add_u32 v8, v10, 4, v8
    v_lshl_add_u32 v9, v10, 4, v9
    v_add_u32 v10, 917504, v8
    v_subrev_u32 v11, 917504, v9
    v_or_b32 v9, s40, v9
    v_or_b32 v11, s40, v11
    v_cndmask_b32 v2, v8, v9, s[82:83]
    v_cndmask_b32 v3, v10, v11, s[82:83]
    v_cndmask_b32 v5, v9, v8, s[82:83]
    v_cndmask_b32 v6, v11, v10, s[82:83]
    s_add_u32 s40, s72, 122880
    v_add_u32_e64 v7, s40, v18
    v_bfe_u32 v10, v0, 1, 2
    v_lshlrev_b32_e64 v10, 4, v10
    v_lshl_add_u32 v10, v23, 3, v10
    v_lshl_add_u32 v10, v22, 6, v10
    v_add_u32 v8, s40, v10
    v_xor_b32 v9, 16, v8
    v_xor_b32 v10, 32, v8
    v_xor_b32 v11, 48, v8
    s_bitcmp1_b32 0x81, s75
    s_cselect_b32 s82, 0, -1
    s_mov_b32 s83, -1
    s_lshl_b32 s38, s75, 6
    v_lshl_add_u32 v14, v22, 5, s74
    v_cvt_f32_u32 v14, v14
    v_cvt_f32_u32_e64 v15, v23
    v_mul_f32 v14, 0x3a000000, v14
    v_mul_f32_e64 v15, 4.0, v15
    v_mul_f32 v12, 0x41000000, v14
    v_mul_f32 v15, v15, v14
    v_cos_f32 v12, v12
    v_fmamk_f32 v112, v14, 0x00000000, v15
    v_fmamk_f32 v114, v14, 0x3f800000, v15
    v_fmamk_f32 v116, v14, 0x40000000, v15
    v_fmamk_f32 v118, v14, 0x40400000, v15
    v_sin_f32 v113, v112
    v_cos_f32 v112, v112
    v_sin_f32 v115, v114
    v_cos_f32 v114, v114
    v_sin_f32 v117, v116
    v_cos_f32 v116, v116
    v_sin_f32 v119, v118
    v_cos_f32 v118, v118
    v_fmamk_f32 v120, v14, 0x41000000, v15
    v_fmamk_f32 v122, v14, 0x41100000, v15
    v_fmamk_f32 v124, v14, 0x41200000, v15
    v_fmamk_f32 v126, v14, 0x41300000, v15
    v_sin_f32 v121, v120
    v_cos_f32 v120, v120
    v_sin_f32 v123, v122
    v_cos_f32 v122, v122
    v_sin_f32 v125, v124
    v_cos_f32 v124, v124
    v_sin_f32 v127, v126
    v_cos_f32 v126, v126
    v_add_f32_e64 v12, v12, v12
    v_cvt_pk_bf16_f32 v32, v112, -v113
    v_cvt_pk_bf16_f32 v33, v114, -v115
    v_cvt_pk_bf16_f32 v34, v116, -v117
    v_cvt_pk_bf16_f32 v35, v118, -v119
    v_pk_fma_f32 v[112:113], v[120:121], v[12:13], v[112:113] op_sel_hi:[1,0,1] neg_lo:[0,0,1] neg_hi:[0,0,1]
    v_pk_fma_f32 v[114:115], v[122:123], v[12:13], v[114:115] op_sel_hi:[1,0,1] neg_lo:[0,0,1] neg_hi:[0,0,1]
    v_pk_fma_f32 v[116:117], v[124:125], v[12:13], v[116:117] op_sel_hi:[1,0,1] neg_lo:[0,0,1] neg_hi:[0,0,1]
    v_pk_fma_f32 v[118:119], v[126:127], v[12:13], v[118:119] op_sel_hi:[1,0,1] neg_lo:[0,0,1] neg_hi:[0,0,1]
    v_cvt_pk_bf16_f32 v36, v120, -v121
    v_cvt_pk_bf16_f32 v37, v122, -v123
    v_cvt_pk_bf16_f32 v38, v124, -v125
    v_cvt_pk_bf16_f32 v39, v126, -v127
    v_pk_fma_f32 v[120:121], v[112:113], v[12:13], v[120:121] op_sel_hi:[1,0,1] neg_lo:[0,0,1] neg_hi:[0,0,1]
    v_pk_fma_f32 v[122:123], v[114:115], v[12:13], v[122:123] op_sel_hi:[1,0,1] neg_lo:[0,0,1] neg_hi:[0,0,1]
    v_pk_fma_f32 v[124:125], v[116:117], v[12:13], v[124:125] op_sel_hi:[1,0,1] neg_lo:[0,0,1] neg_hi:[0,0,1]
    v_pk_fma_f32 v[126:127], v[118:119], v[12:13], v[126:127] op_sel_hi:[1,0,1] neg_lo:[0,0,1] neg_hi:[0,0,1]
    v_cvt_pk_bf16_f32 v40, v112, -v113
    v_cvt_pk_bf16_f32 v41, v114, -v115
    v_cvt_pk_bf16_f32 v42, v116, -v117
    v_cvt_pk_bf16_f32 v43, v118, -v119
    v_pk_fma_f32 v[112:113], v[120:121], v[12:13], v[112:113] op_sel_hi:[1,0,1] neg_lo:[0,0,1] neg_hi:[0,0,1]
    v_pk_fma_f32 v[114:115], v[122:123], v[12:13], v[114:115] op_sel_hi:[1,0,1] neg_lo:[0,0,1] neg_hi:[0,0,1]
    v_pk_fma_f32 v[116:117], v[124:125], v[12:13], v[116:117] op_sel_hi:[1,0,1] neg_lo:[0,0,1] neg_hi:[0,0,1]
    v_pk_fma_f32 v[118:119], v[126:127], v[12:13], v[118:119] op_sel_hi:[1,0,1] neg_lo:[0,0,1] neg_hi:[0,0,1]
    v_cvt_pk_bf16_f32 v44, v120, -v121
    v_cvt_pk_bf16_f32 v45, v122, -v123
    v_cvt_pk_bf16_f32 v46, v124, -v125
    v_cvt_pk_bf16_f32 v47, v126, -v127
    v_pk_fma_f32 v[120:121], v[112:113], v[12:13], v[120:121] op_sel_hi:[1,0,1] neg_lo:[0,0,1] neg_hi:[0,0,1]
    v_pk_fma_f32 v[122:123], v[114:115], v[12:13], v[122:123] op_sel_hi:[1,0,1] neg_lo:[0,0,1] neg_hi:[0,0,1]
    v_pk_fma_f32 v[124:125], v[116:117], v[12:13], v[124:125] op_sel_hi:[1,0,1] neg_lo:[0,0,1] neg_hi:[0,0,1]
    v_pk_fma_f32 v[126:127], v[118:119], v[12:13], v[126:127] op_sel_hi:[1,0,1] neg_lo:[0,0,1] neg_hi:[0,0,1]
    v_cvt_pk_bf16_f32 v48, v112, -v113
    v_cvt_pk_bf16_f32 v49, v114, -v115
    v_cvt_pk_bf16_f32 v50, v116, -v117
    v_cvt_pk_bf16_f32 v51, v118, -v119
    v_pk_fma_f32 v[112:113], v[120:121], v[12:13], v[112:113] op_sel_hi:[1,0,1] neg_lo:[0,0,1] neg_hi:[0,0,1]
    v_pk_fma_f32 v[114:115], v[122:123], v[12:13], v[114:115] op_sel_hi:[1,0,1] neg_lo:[0,0,1] neg_hi:[0,0,1]
    v_pk_fma_f32 v[116:117], v[124:125], v[12:13], v[116:117] op_sel_hi:[1,0,1] neg_lo:[0,0,1] neg_hi:[0,0,1]
    v_pk_fma_f32 v[118:119], v[126:127], v[12:13], v[118:119] op_sel_hi:[1,0,1] neg_lo:[0,0,1] neg_hi:[0,0,1]
    v_cvt_pk_bf16_f32 v52, v120, -v121
    v_cvt_pk_bf16_f32 v53, v122, -v123
    v_cvt_pk_bf16_f32 v54, v124, -v125
    v_cvt_pk_bf16_f32 v55, v126, -v127
    v_pk_fma_f32 v[120:121], v[112:113], v[12:13], v[120:121] op_sel_hi:[1,0,1] neg_lo:[0,0,1] neg_hi:[0,0,1]
    v_pk_fma_f32 v[122:123], v[114:115], v[12:13], v[122:123] op_sel_hi:[1,0,1] neg_lo:[0,0,1] neg_hi:[0,0,1]
    v_pk_fma_f32 v[124:125], v[116:117], v[12:13], v[124:125] op_sel_hi:[1,0,1] neg_lo:[0,0,1] neg_hi:[0,0,1]
    v_pk_fma_f32 v[126:127], v[118:119], v[12:13], v[126:127] op_sel_hi:[1,0,1] neg_lo:[0,0,1] neg_hi:[0,0,1]
    v_cvt_pk_bf16_f32 v56, v112, -v113
    v_cvt_pk_bf16_f32 v57, v114, -v115
    v_cvt_pk_bf16_f32 v58, v116, -v117
    v_cvt_pk_bf16_f32 v59, v118, -v119
    v_cvt_pk_bf16_f32 v60, v120, -v121
    v_cvt_pk_bf16_f32 v61, v122, -v123
    v_cvt_pk_bf16_f32 v62, v124, -v125
    v_cvt_pk_bf16_f32 v63, v126, -v127
    s_cmp_eq_u64 s[78:79], 0
    s_cbranch_scc1 gl_8
    s_mov_b32 s42, 0x100000
spin_9:
    ds_read_b32 v27, v19 offset:0
    s_waitcnt lgkmcnt(0)
    v_cmp_gt_u32 vcc, 4, v27
    s_sub_u32 s42, s42, 1
    s_cbranch_vccz spinx_10
    s_sleep 1
    s_cbranch_scc0 spin_9
spinx_10:
    s_mov_b32 s42, 0x20000
poll_11:
    buffer_load_dword v16, v20, s[24:27], 0 offen sc1
    s_waitcnt vmcnt(0)
    v_cmp_gt_u32 vcc, 1, v16
    s_sub_u32 s42, s42, 1
    s_cbranch_vccz pollx_12
    s_sleep 4
    s_cbranch_scc0 poll_11
pollx_12:
    s_add_u32 m0, s72, 143360
    s_add_u32 s39, s73, 3936256
    buffer_load_dwordx4 v31, s[24:27], s39 offen sc1 lds
    s_add_u32 m0, s72, 144384
    s_add_u32 s39, s73, 3943424
    buffer_load_dwordx4 v31, s[24:27], s39 offen sc1 lds
    s_add_u32 m0, s72, 145408
    s_add_u32 s39, s73, 3950592
    buffer_load_dwordx4 v31, s[24:27], s39 offen sc1 lds
    s_add_u32 m0, s72, 146432
    s_add_u32 s39, s73, 3957760
    buffer_load_dwordx4 v31, s[24:27], s39 offen sc1 lds
gl_8:
    s_waitcnt vmcnt(0)
    ds_write_b32 v21, v25
    s_mov_b32 s42, 0x100000
spin_13:
    ds_read_b32 v27, v19 offset:0
    s_waitcnt lgkmcnt(0)
    v_cmp_gt_u32_e64 vcc, 5, v27
    s_sub_u32 s42, s42, 1
    s_cbranch_vccz spinx_14
    s_cbranch_scc0 spin_13
spinx_14:
    ds_read2st64_b32 v[160:161], v28 offset0:0 offset1:1
    ds_read2st64_b32 v[162:163], v28 offset0:2 offset1:3
    ds_read2st64_b32 v[192:193], v29 offset0:0 offset1:1
    ds_read2st64_b32 v[194:195], v29 offset0:2 offset1:3
    ds_read2st64_b32 v[164:165], v28 offset0:8 offset1:9
    ds_read2st64_b32 v[166:167], v28 offset0:10 offset1:11
    ds_read2st64_b32 v[196:197], v29 offset0:8 offset1:9
    ds_read2st64_b32 v[198:199], v29 offset0:10 offset1:11
    ds_read2st64_b32 v[168:169], v28 offset0:16 offset1:17
    ds_read2st64_b32 v[170:171], v28 offset0:18 offset1:19
    ds_read2st64_b32 v[200:201], v29 offset0:16 offset1:17
    ds_read2st64_b32 v[202:203], v29 offset0:18 offset1:19
    s_cmp_eq_u32 s76, 0
    s_cbranch_scc0 L_B_gspecial
    s_waitcnt lgkmcnt(8)
    ds_read2st64_b32 v[172:173], v28 offset0:24 offset1:25
    ds_read2st64_b32 v[174:175], v28 offset0:26 offset1:27
    ds_read2st64_b32 v[204:205], v29 offset0:24 offset1:25
    ds_read2st64_b32 v[206:207], v29 offset0:26 offset1:27
    v_mfma_f32_32x32x16_bf16 v[80:95], v[192:195], v[32:35], 0
    v_mfma_f32_32x32x16_bf16 v[64:79], v[160:163], v[32:35], 0
    s_waitcnt lgkmcnt(8)
    ds_read2st64_b32 v[176:177], v28 offset0:32 offset1:33
    ds_read2st64_b32 v[178:179], v28 offset0:34 offset1:35
    ds_read2st64_b32 v[208:209], v29 offset0:32 offset1:33
    ds_read2st64_b32 v[210:211], v29 offset0:34 offset1:35
    v_mfma_f32_32x32x16_bf16 v[80:95], v[196:199], v[36:39], v[80:95]
    v_mfma_f32_32x32x16_bf16 v[64:79], v[164:167], v[36:39], v[64:79]
    s_waitcnt lgkmcnt(8)
    ds_read2st64_b32 v[180:181], v28 offset0:40 offset1:41
    ds_read2st64_b32 v[182:183], v28 offset0:42 offset1:43
    ds_read2st64_b32 v[212:213], v29 offset0:40 offset1:41
    ds_read2st64_b32 v[214:215], v29 offset0:42 offset1:43
    v_mfma_f32_32x32x16_bf16 v[80:95], v[200:203], v[40:43], v[80:95]
    v_mfma_f32_32x32x16_bf16 v[64:79], v[168:171], v[40:43], v[64:79]
    s_waitcnt lgkmcnt(8)
    ds_read2st64_b32 v[184:185], v28 offset0:48 offset1:49
    ds_read2st64_b32 v[186:187], v28 offset0:50 offset1:51
    ds_read2st64_b32 v[216:217], v29 offset0:48 offset1:49
    ds_read2st64_b32 v[218:219], v29 offset0:50 offset1:51
    v_mfma_f32_32x32x16_bf16 v[80:95], v[204:207], v[44:47], v[80:95]
    v_mfma_f32_32x32x16_bf16 v[64:79], v[172:175], v[44:47], v[64:79]
    s_waitcnt lgkmcnt(8)
    ds_read2st64_b32 v[188:189], v28 offset0:56 offset1:57
    ds_read2st64_b32 v[190:191], v28 offset0:58 offset1:59
    ds_read2st64_b32 v[220:221], v29 offset0:56 offset1:57
    ds_read2st64_b32 v[222:223], v29 offset0:58 offset1:59
    v_mfma_f32_32x32x16_bf16 v[80:95], v[208:211], v[48:51], v[80:95]
    v_mfma_f32_32x32x16_bf16 v[64:79], v[176:179], v[48:51], v[64:79]
    s_waitcnt lgkmcnt(8)
    v_mfma_f32_32x32x16_bf16 v[80:95], v[212:215], v[52:55], v[80:95]
    v_mfma_f32_32x32x16_bf16 v[64:79], v[180:183], v[52:55], v[64:79]
    s_waitcnt lgkmcnt(4)
    v_mfma_f32_32x32x16_bf16 v[80:95], v[216:219], v[56:59], v[80:95]
    v_mfma_f32_32x32x16_bf16 v[64:79], v[184:187], v[56:59], v[64:79]
    s_waitcnt lgkmcnt(0)
    v_mfma_f32_32x32x16_bf16 v[80:95], v[220:223], v[60:63], v[80:95]
    v_mfma_f32_32x32x16_bf16 v[64:79], v[188:191], v[60:63], v[64:79]
L_B_gdone:
    s_nop 10
    v_cndmask_b32 v80, 0, v80, s[82:83]
    v_pk_add_f32 v[96:97], v[64:65], v[80:81] neg_lo:[0,1] neg_hi:[0,1]
    v_pk_add_f32 v[98:99], v[66:67], v[82:83] neg_lo:[0,1] neg_hi:[0,1]
    v_pk_add_f32 v[100:101], v[68:69], v[84:85] neg_lo:[0,1] neg_hi:[0,1]
    v_pk_add_f32 v[102:103], v[70:71], v[86:87] neg_lo:[0,1] neg_hi:[0,1]
    v_pk_add_f32 v[104:105], v[72:73], v[88:89] neg_lo:[0,1] neg_hi:[0,1]
    v_pk_add_f32 v[106:107], v[74:75], v[90:91] neg_lo:[0,1] neg_hi:[0,1]
    v_pk_add_f32 v[108:109], v[76:77], v[92:93] neg_lo:[0,1] neg_hi:[0,1]
    v_pk_add_f32 v[110:111], v[78:79], v[94:95] neg_lo:[0,1] neg_hi:[0,1]
    v_cvt_pk_bf16_f32 v224, v96, v97
    v_cvt_pk_bf16_f32 v225, v98, v99
    v_cvt_pk_bf16_f32 v226, v100, v101
    v_cvt_pk_bf16_f32 v227, v102, v103
    v_cvt_pk_bf16_f32 v228, v104, v105
    v_cvt_pk_bf16_f32 v229, v106, v107
    v_cvt_pk_bf16_f32 v230, v108, v109
    v_cvt_pk_bf16_f32 v231, v110, v111
    ds_write_b64 v8, v[224:225] offset:0
    ds_write_b64 v9, v[226:227] offset:0
    ds_write_b64 v10, v[228:229] offset:0
    ds_write_b64 v11, v[230:231] offset:0
    ds_read_b128 v[160:163], v7 offset:0
    ds_read_b128 v[164:167], v7 offset:1024
    v_pk_add_f32 v[112:113], v[64:65], v[80:81]
    v_pk_add_f32 v[114:115], v[66:67], v[82:83]
    v_pk_add_f32 v[116:117], v[68:69], v[84:85]
    v_pk_add_f32 v[118:119], v[70:71], v[86:87]
    v_pk_add_f32 v[120:121], v[72:73], v[88:89]
    v_pk_add_f32 v[122:123], v[74:75], v[90:91]
    v_pk_add_f32 v[124:125], v[76:77], v[92:93]
    v_pk_add_f32 v[126:127], v[78:79], v[94:95]
    v_cvt_pk_bf16_f32 v232, v112, v113
    v_cvt_pk_bf16_f32 v233, v114, v115
    v_cvt_pk_bf16_f32 v234, v116, v117
    v_cvt_pk_bf16_f32 v235, v118, v119
    v_cvt_pk_bf16_f32 v236, v120, v121
    v_cvt_pk_bf16_f32 v237, v122, v123
    v_cvt_pk_bf16_f32 v238, v124, v125
    v_cvt_pk_bf16_f32 v239, v126, v127
    ds_write_b64 v8, v[232:233] offset:2048
    ds_write_b64 v9, v[234:235] offset:2048
    ds_write_b64 v10, v[236:237] offset:2048
    ds_write_b64 v11, v[238:239] offset:2048
    ds_read_b128 v[168:171], v7 offset:2048
    ds_read_b128 v[172:175], v7 offset:3072
    s_mov_b32 s42, 0x100000
spin_15:
    ds_read_b32 v27, v19 offset:16
    s_waitcnt lgkmcnt(0)
    v_cmp_gt_u32 vcc, 12, v27
    s_sub_u32 s42, s42, 1
    s_cbranch_vccz spinx_16
    s_sleep 1
    s_cbranch_scc0 spin_15
spinx_16:
    s_waitcnt lgkmcnt(7)
    buffer_store_dwordx4 v[160:163], v2, s[28:31], s38 offen sc1 nt
    s_waitcnt lgkmcnt(6)
    buffer_store_dwordx4 v[164:167], v3, s[28:31], s38 offen sc1 nt
    s_waitcnt lgkmcnt(1)
    buffer_store_dwordx4 v[168:171], v5, s[28:31], s38 offen sc1 nt
    s_waitcnt lgkmcnt(0)
    buffer_store_dwordx4 v[172:175], v6, s[28:31], s38 offen sc1 nt
L_B_done:
    s_endpgm
    s_nop 0
L_B_N:
    s_cmp_lg_u32 s37, 0
    s_cbranch_scc1 L_B_nogo
    s_mov_b32 s38, 1
    s_waitcnt vmcnt(0)
    s_atomic_add s38, s[22:23], 0x0 glc
    s_waitcnt lgkmcnt(0)
    s_and_b32 s38, s38, 31
    s_cmp_eq_u32 s38, 31
    s_cbranch_scc0 L_B_nogo
    s_atomic_add s0, s[22:23], 0x80
L_B_nogo:
    s_cmp_ge_u32 s33, 14
    s_cselect_b32 s40, 14, 0
    s_addc_u32 s74, s32, s32
    s_sub_u32 s75, s33, s40
    s_cmp_eq_u32 s74, 0
    s_cselect_b32 s40, 3, 2
    s_cselect_b32 s76, 1, 0
    s_lshl2_add_u32 s38, s74, s37
    s_mul_i32 s73, s38, 28672
    s_lshl_b32 s38, s75, 5
    s_sub_u32 s39, 417, s38
    v_mov_b32 v32, s38
    v_mov_b32_e64 v33, s39
    s_mov_b32 vcc_lo, 0xff00ff00
    s_mov_b32 vcc_hi, vcc_lo
    v_cndmask_b32 v34, v32, v33, vcc
    v_and_b32_e64 v35, 7, v0
    v_lshl_add_u32 v35, v35, 2, v34
    v_lshrrev_b32_e64 v36, 4, v0
    v_mul_u32_u24 v36, 448, v36
    v_add_lshl_u32 v31, v35, v36, 2
    v_bfe_u32 v35, v0, 1, 1
    v_mad_u32_u24 v34, v35, 31, v34
    v_min_u32 v34, 447, v34
    v_lshrrev_b32 v35, 5, v34
    v_and_b32 v36, 1, v0
    v_lshl_add_u32 v35, v35, 1, v36
    v_cmp_gt_u32 vcc, 256, v34
    v_add_u32 v34, 512, v34
    v_mul_u32_u24 v34, 1366, v34
    v_lshrrev_b32 v34, 16, v34
    v_cndmask_b32 v34, v34, v35, vcc
    v_lshlrev_b32_e64 v34, 7, v34
    v_add_u32 v20, 1929216, v34
    s_add_u32 s74, s82, s74
    s_cmp_eq_u32 s37, 2
    s_cselect_b32 s74, 16, s74
    s_cselect_b32 s76, 2, s76
    s_cmp_ge_u32 s37, s40
    s_cselect_b32 s76, 3, s76
    v_lshlrev_b32 v32, 2, v23
    v_sub_u32 v32, v22, v32
    v_cmp_le_i32 s[4:5], 0, v32
    v_cmp_le_i32 s[6:7], 1, v32
    v_cmp_le_i32 s[8:9], 2, v32
    v_cmp_le_i32 s[10:11], 3, v32
    v_cmp_le_i32 s[12:13], 8, v32
    v_cmp_le_i32 s[14:15], 9, v32
    v_cmp_le_i32 s[16:17], 10, v32
    v_cmp_le_i32 s[18:19], 11, v32
    v_cmp_le_i32 s[56:57], 16, v32
    v_cmp_le_i32 s[58:59], 17, v32
    v_cmp_le_i32 s[60:61], 18, v32
    v_cmp_le_i32 s[62:63], 19, v32
    v_cmp_le_i32 s[64:65], 24, v32
    v_cmp_le_i32 s[66:67], 25, v32
    v_cmp_le_i32 s[68:69], 26, v32
    v_cmp_le_i32 s[70:71], 27, v32
    v_mov_b32 v33, 0xffff
    v_cndmask_b32 v240, 0, v33, s[4:5]
    v_cndmask_b32 v240, v240, -1, s[6:7]
    v_cndmask_b32 v241, 0, v33, s[8:9]
    v_cndmask_b32 v241, v241, -1, s[10:11]
    v_cndmask_b32 v242, 0, v33, s[12:13]
    v_cndmask_b32 v242, v242, -1, s[14:15]
    v_cndmask_b32 v243, 0, v33, s[16:17]
    v_cndmask_b32 v243, v243, -1, s[18:19]
    v_cndmask_b32 v244, 0, v33, s[56:57]
    v_cndmask_b32 v244, v244, -1, s[58:59]
    v_cndmask_b32 v245, 0, v33, s[60:61]
    v_cndmask_b32 v245, v245, -1, s[62:63]
    v_cndmask_b32 v246, 0, v33, s[64:65]
    v_cndmask_b32 v246, v246, -1, s[66:67]
    v_cndmask_b32 v247, 0, v33, s[68:69]
    v_cndmask_b32 v247, v247, -1, s[70:71]
    s_lshl_b32 s41, s37, 12
    s_barrier
    s_mov_b64 s[20:21], s[48:49]
    s_mov_b64 s[48:49], s[100:101]
    s_mov_b32 s50, 1204224
    s_add_u32 m0, s82, 131072
    s_bfe_u32 s39, s1, 0x30000
    s_mul_i32 s39, s39, 172032
    s_add_u32 s39, s39, s34
    buffer_load_dwordx4 v89, s[48:51], s39 offen lds
    s_add_u32 m0, s82, 135168
    s_bfe_u32 s39, s1, 0x30004
    s_mul_i32 s39, s39, 172032
    s_add_u32 s39, s39, s34
    buffer_load_dwordx4 v89, s[48:51], s39 offen lds
    s_mov_b64 s[48:49], s[20:21]
    s_mov_b32 s50, 1835008
    s_add_u32 m0, s41, 0
    s_bfe_u32 s45, s1, 0x30000
    s_mul_i32 s45, s45, 128
    s_add_u32 s45, s45, s52
    buffer_load_dwordx4 v8, s[48:51], s45 offen offset:0 lds
    buffer_load_dwordx4 v9, s[48:51], s45 offen offset:1024 lds
    buffer_load_dwordx4 v10, s[48:51], s45 offen offset:2048 lds
    buffer_load_dwordx4 v11, s[48:51], s45 offen offset:3072 lds
    s_add_u32 m0, s41, 16384
    s_bfe_u32 s45, s1, 0x30004
    s_mul_i32 s45, s45, 128
    s_add_u32 s45, s45, s52
    buffer_load_dwordx4 v8, s[48:51], s45 offen offset:0 lds
    buffer_load_dwordx4 v9, s[48:51], s45 offen offset:1024 lds
    buffer_load_dwordx4 v10, s[48:51], s45 offen offset:2048 lds
    buffer_load_dwordx4 v11, s[48:51], s45 offen offset:3072 lds
    s_add_u32 m0, s41, 32768
    s_bfe_u32 s45, s1, 0x30008
    s_mul_i32 s45, s45, 128
    s_add_u32 s45, s45, s52
    buffer_load_dwordx4 v8, s[48:51], s45 offen offset:0 lds
    buffer_load_dwordx4 v9, s[48:51], s45 offen offset:1024 lds
    buffer_load_dwordx4 v10, s[48:51], s45 offen offset:2048 lds
    buffer_load_dwordx4 v11, s[48:51], s45 offen offset:3072 lds
    s_add_u32 m0, s41, 49152
    s_bfe_u32 s45, s1, 0x3000c
    s_mul_i32 s45, s45, 128
    s_add_u32 s45, s45, s52
    buffer_load_dwordx4 v8, s[48:51], s45 offen offset:0 lds
    buffer_load_dwordx4 v9, s[48:51], s45 offen offset:1024 lds
    buffer_load_dwordx4 v10, s[48:51], s45 offen offset:2048 lds
    buffer_load_dwordx4 v11, s[48:51], s45 offen offset:3072 lds
    s_waitcnt vmcnt(12)
    ds_read_b128 v[128:131], v12 offset:0
    ds_read_b128 v[132:135], v13 offset:0
    ds_read_b128 v[136:139], v14 offset:0
    ds_read_b128 v[140:143], v15 offset:0
    s_waitcnt lgkmcnt(0)
    s_add_u32 m0, s41, 0
    s_bfe_u32 s45, s1, 0x30010
    s_mul_i32 s45, s45, 128
    s_add_u32 s45, s45, s52
    buffer_load_dwordx4 v8, s[48:51], s45 offen offset:0 lds
    buffer_load_dwordx4 v9, s[48:51], s45 offen offset:1024 lds
    buffer_load_dwordx4 v10, s[48:51], s45 offen offset:2048 lds
    buffer_load_dwordx4 v11, s[48:51], s45 offen offset:3072 lds
    s_waitcnt vmcnt(12)
    ds_read_b128 v[144:147], v12 offset:16384
    ds_read_b128 v[148:151], v13 offset:16384
    ds_read_b128 v[152:155], v14 offset:16384
    ds_read_b128 v[156:159], v15 offset:16384
    s_waitcnt lgkmcnt(0)
    s_add_u32 m0, s41, 16384
    s_bfe_u32 s45, s1, 0x30014
    s_mul_i32 s45, s45, 128
    s_add_u32 s45, s45, s52
    buffer_load_dwordx4 v8, s[48:51], s45 offen offset:0 lds
    buffer_load_dwordx4 v9, s[48:51], s45 offen offset:1024 lds
    buffer_load_dwordx4 v10, s[48:51], s45 offen offset:2048 lds
    buffer_load_dwordx4 v11, s[48:51], s45 offen offset:3072 lds
    s_waitcnt vmcnt(12)
    ds_read_b128 v[160:163], v12 offset:32768
    ds_read_b128 v[164:167], v13 offset:32768
    ds_read_b128 v[168:171], v14 offset:32768
    ds_read_b128 v[172:175], v15 offset:32768
    s_waitcnt lgkmcnt(0)
    s_add_u32 m0, s41, 32768
    s_bfe_u32 s45, s1, 0x30018
    s_mul_i32 s45, s45, 128
    s_add_u32 s45, s45, s52
    buffer_load_dwordx4 v8, s[48:51], s45 offen offset:0 lds
    buffer_load_dwordx4 v9, s[48:51], s45 offen offset:1024 lds
    buffer_load_dwordx4 v10, s[48:51], s45 offen offset:2048 lds
    buffer_load_dwordx4 v11, s[48:51], s45 offen offset:3072 lds
    s_waitcnt vmcnt(12)
    ds_read_b128 v[176:179], v12 offset:49152
    ds_read_b128 v[180:183], v13 offset:49152
    ds_read_b128 v[184:187], v14 offset:49152
    ds_read_b128 v[188:191], v15 offset:49152
    global_load_dword v90, v24, s[22:23] offset:128 sc1
    s_mov_b64 s[48:49], s[100:101]
    s_mov_b32 s50, 1204224
    s_add_u32 m0, s82, 139264
    s_bfe_u32 s39, s1, 0x30008
    s_mul_i32 s39, s39, 172032
    s_add_u32 s39, s39, s34
    buffer_load_dwordx4 v89, s[48:51], s39 offen lds
    s_add_u32 m0, s82, 143360
    s_bfe_u32 s39, s1, 0x3000c
    s_mul_i32 s39, s39, 172032
    s_add_u32 s39, s39, s34
    buffer_load_dwordx4 v89, s[48:51], s39 offen lds
    s_waitcnt lgkmcnt(0)
    s_waitcnt vmcnt(11)
    ds_read_b128 v[192:195], v12 offset:0
    ds_read_b128 v[196:199], v13 offset:0
    ds_read_b128 v[200:203], v14 offset:0
    ds_read_b128 v[204:207], v15 offset:0
    s_add_u32 m0, s82, 147456
    s_bfe_u32 s39, s1, 0x30010
    s_mul_i32 s39, s39, 172032
    s_add_u32 s39, s39, s34
    buffer_load_dwordx4 v89, s[48:51], s39 offen lds
    s_add_u32 m0, s82, 151552
    s_bfe_u32 s39, s1, 0x30014
    s_mul_i32 s39, s39, 172032
    s_add_u32 s39, s39, s34
    buffer_load_dwordx4 v89, s[48:51], s39 offen lds
    s_waitcnt lgkmcnt(0)
    s_waitcnt vmcnt(9)
    ds_read_b128 v[208:211], v12 offset:16384
    ds_read_b128 v[212:215], v13 offset:16384
    ds_read_b128 v[216:219], v14 offset:16384
    ds_read_b128 v[220:223], v15 offset:16384
    s_add_u32 m0, s82, 155648
    s_bfe_u32 s39, s1, 0x30018
    s_mul_i32 s39, s39, 172032
    s_add_u32 s39, s39, s34
    buffer_load_dwordx4 v89, s[48:51], s39 offen lds
    s_waitcnt lgkmcnt(0)
    s_waitcnt vmcnt(6)
    ds_read_b128 v[224:227], v12 offset:32768
    ds_read_b128 v[228:231], v13 offset:32768
    ds_read_b128 v[232:235], v14 offset:32768
    ds_read_b128 v[236:239], v15 offset:32768
    s_waitcnt lgkmcnt(0)
    s_waitcnt vmcnt(5)
    v_cmp_le_u32 vcc, 1, v90
    s_nop 0
    s_cbranch_vccz L_B_gowait
L_B_goP:
    ds_write_b32 v21, v26
    s_setprio 1
    s_mov_b32 s42, 0x100000
spin_17:
    ds_read_b32 v27, v19 offset:0
    s_waitcnt lgkmcnt(0)
    v_cmp_gt_u32 vcc, 1, v27
    s_sub_u32 s42, s42, 1
    s_cbranch_vccz spinx_18
    s_cbranch_scc0 spin_17
spinx_18:
    s_waitcnt vmcnt(3)
    s_branch L_B_Q
L_B_qwait:
    s_mov_b32 s42, 0x100000
spin_19:
    ds_read_b32 v27, v19 offset:0
    s_waitcnt lgkmcnt(0)
    v_cmp_gt_u32 vcc, 3, v27
    s_sub_u32 s42, s42, 1
    s_cbranch_vccz spinx_20
    s_cbranch_scc0 spin_19
spinx_20:
    s_branch L_B_qok
    s_nop 0
L_B_clear:
    s_cmp_lg_u32 s37, 0
    s_cbranch_scc1 L_B_cleared
    s_lshl3_add_u32 s38, s38, s32
    s_mul_i32 s38, s38, 3072
    s_add_u32 s38, s38, 1835008
    v_mov_b64 v[64:65], 0
    v_mov_b64 v[66:67], 0
    buffer_store_dwordx4 v[64:67], v18, s[24:27], s38 offen offset:0 sc1
    buffer_store_dwordx4 v[64:67], v18, s[24:27], s38 offen offset:1024 sc1
    buffer_store_dwordx4 v[64:67], v18, s[24:27], s38 offen offset:2048 sc1
    s_branch L_B_cleared
    s_nop 0
L_B_gowait:
    s_mov_b32 s42, 0x20000
L_B_gw:
    global_load_dword v90, v24, s[22:23] offset:128 sc1
    s_waitcnt vmcnt(0)
    v_cmp_le_u32 vcc, 1, v90
    s_sub_u32 s42, s42, 1
    s_cbranch_vccnz L_B_gox
    s_sleep 2
    s_cbranch_scc0 L_B_gw
L_B_gox:
    s_cmp_eq_u32 s43, 0
    s_cbranch_scc1 L_B_goP
    s_branch L_B_go
    s_nop 0
L_B_notask:
    s_cmp_eq_u64 s[78:79], 0
    s_cbranch_scc1 gl_21
    s_mov_b32 s42, 0x100000
spin_22:
    ds_read_b32 v27, v19 offset:0
    s_waitcnt lgkmcnt(0)
    v_cmp_gt_u32 vcc, 4, v27
    s_sub_u32 s42, s42, 1
    s_cbranch_vccz spinx_23
    s_sleep 1
    s_cbranch_scc0 spin_22
spinx_23:
    s_mov_b32 s42, 0x20000
poll_24:
    buffer_load_dword v16, v20, s[24:27], 0 offen sc1
    s_waitcnt vmcnt(0)
    v_cmp_gt_u32 vcc, 1, v16
    s_sub_u32 s42, s42, 1
    s_cbranch_vccz pollx_25
    s_sleep 4
    s_cbranch_scc0 poll_24
pollx_25:
    s_add_u32 m0, s72, 143360
    s_add_u32 s39, s73, 3936256
    buffer_load_dwordx4 v31, s[24:27], s39 offen sc1 lds
    s_add_u32 m0, s72, 144384
    s_add_u32 s39, s73, 3943424
    buffer_load_dwordx4 v31, s[24:27], s39 offen sc1 lds
    s_add_u32 m0, s72, 145408
    s_add_u32 s39, s73, 3950592
    buffer_load_dwordx4 v31, s[24:27], s39 offen sc1 lds
    s_add_u32 m0, s72, 146432
    s_add_u32 s39, s73, 3957760
    buffer_load_dwordx4 v31, s[24:27], s39 offen sc1 lds
gl_21:
    s_waitcnt vmcnt(0)
    ds_write_b32 v21, v25
    s_branch L_B_done
    s_nop 0
L_B_nog:
    s_waitcnt vmcnt(0)
    s_atomic_add s0, s[46:47], s21 offset:73728
    s_branch L_B_done
    s_nop 0
L_B_vwait:
    s_mov_b32 s42, 0x100000
spin_26:
    ds_read_b32 v27, v19 offset:16
    s_waitcnt lgkmcnt(0)
    v_cmp_gt_u32 vcc, 3, v27
    s_sub_u32 s42, s42, 1
    s_cbranch_vccz spinx_27
    s_cbranch_scc0 spin_26
spinx_27:
    s_branch L_B_vok
    s_nop 0
L_B_noold:
    s_nop 8
    v_mov_b32 v80, 0xff800000
    v_mov_b32 v81, 0xff800000
    v_mov_b32 v82, 0xff800000
    v_mov_b32 v83, 0xff800000
    v_mov_b32 v84, 0xff800000
    v_mov_b32 v85, 0xff800000
    v_mov_b32 v86, 0xff800000
    v_mov_b32 v87, 0xff800000
    v_mov_b32 v88, 0xff800000
    v_mov_b32 v89, 0xff800000
    v_mov_b32 v90, 0xff800000
    v_mov_b32 v91, 0xff800000
    v_mov_b32 v92, 0xff800000
    v_mov_b32 v93, 0xff800000
    v_mov_b32 v94, 0xff800000
    v_mov_b32 v95, 0xff800000
    s_branch L_B_merge
L_B_gspecial:
    s_cmp_eq_u32 s76, 1
    s_cselect_b32 s39, 0, 16
    s_cselect_b32 s40, 0, 0x80000000
    s_cselect_b32 s41, 0x02020000, 0
    s_add_u32 s41, s41, 0x01000c0c
    s_waitcnt lgkmcnt(8)
    ds_read2st64_b32 v[172:173], v28 offset0:24 offset1:25
    ds_read2st64_b32 v[174:175], v28 offset0:26 offset1:27
    ds_read2st64_b32 v[204:205], v29 offset0:24 offset1:25
    ds_read2st64_b32 v[206:207], v29 offset0:26 offset1:27
    v_perm_b32 v192, v192, v192, s41
    v_xor_b32_e64 v192, s40, v192
    v_perm_b32 v193, v193, v193, s41
    v_xor_b32_e64 v193, s40, v193
    v_perm_b32 v194, v194, v194, s41
    v_xor_b32_e64 v194, s40, v194
    v_perm_b32 v195, v195, v195, s41
    v_xor_b32_e64 v195, s40, v195
    v_bfe_u32 v160, v160, s39, 16
    v_bfe_u32 v161, v161, s39, 16
    v_bfe_u32 v162, v162, s39, 16
    v_bfe_u32 v163, v163, s39, 16
    v_mfma_f32_32x32x16_bf16 v[80:95], v[192:195], v[32:35], 0
    s_nop 0
    v_mfma_f32_32x32x16_bf16 v[64:79], v[160:163], v[32:35], 0
    s_waitcnt lgkmcnt(8)
    ds_read2st64_b32 v[176:177], v28 offset0:32 offset1:33
    ds_read2st64_b32 v[178:179], v28 offset0:34 offset1:35
    ds_read2st64_b32 v[208:209], v29 offset0:32 offset1:33
    ds_read2st64_b32 v[210:211], v29 offset0:34 offset1:35
    v_perm_b32 v196, v196, v196, s41
    v_xor_b32_e64 v196, s40, v196
    v_perm_b32 v197, v197, v197, s41
    v_xor_b32_e64 v197, s40, v197
    v_perm_b32 v198, v198, v198, s41
    v_xor_b32_e64 v198, s40, v198
    v_perm_b32 v199, v199, v199, s41
    v_xor_b32_e64 v199, s40, v199
    v_bfe_u32 v164, v164, s39, 16
    v_bfe_u32 v165, v165, s39, 16
    v_bfe_u32 v166, v166, s39, 16
    v_bfe_u32 v167, v167, s39, 16
    v_mfma_f32_32x32x16_bf16 v[80:95], v[196:199], v[36:39], v[80:95]
    s_nop 0
    v_mfma_f32_32x32x16_bf16 v[64:79], v[164:167], v[36:39], v[64:79]
    s_waitcnt lgkmcnt(8)
    ds_read2st64_b32 v[180:181], v28 offset0:40 offset1:41
    ds_read2st64_b32 v[182:183], v28 offset0:42 offset1:43
    ds_read2st64_b32 v[212:213], v29 offset0:40 offset1:41
    ds_read2st64_b32 v[214:215], v29 offset0:42 offset1:43
    v_perm_b32 v200, v200, v200, s41
    v_xor_b32_e64 v200, s40, v200
    v_perm_b32 v201, v201, v201, s41
    v_xor_b32_e64 v201, s40, v201
    v_perm_b32 v202, v202, v202, s41
    v_xor_b32_e64 v202, s40, v202
    v_perm_b32 v203, v203, v203, s41
    v_xor_b32_e64 v203, s40, v203
    v_bfe_u32 v168, v168, s39, 16
    v_bfe_u32 v169, v169, s39, 16
    v_bfe_u32 v170, v170, s39, 16
    v_bfe_u32 v171, v171, s39, 16
    v_mfma_f32_32x32x16_bf16 v[80:95], v[200:203], v[40:43], v[80:95]
    s_nop 0
    v_mfma_f32_32x32x16_bf16 v[64:79], v[168:171], v[40:43], v[64:79]
    s_waitcnt lgkmcnt(8)
    ds_read2st64_b32 v[184:185], v28 offset0:48 offset1:49
    ds_read2st64_b32 v[186:187], v28 offset0:50 offset1:51
    ds_read2st64_b32 v[216:217], v29 offset0:48 offset1:49
    ds_read2st64_b32 v[218:219], v29 offset0:50 offset1:51
    v_perm_b32 v204, v204, v204, s41
    v_xor_b32_e64 v204, s40, v204
    v_perm_b32 v205, v205, v205, s41
    v_xor_b32_e64 v205, s40, v205
    v_perm_b32 v206, v206, v206, s41
    v_xor_b32_e64 v206, s40, v206
    v_perm_b32 v207, v207, v207, s41
    v_xor_b32_e64 v207, s40, v207
    v_bfe_u32 v172, v172, s39, 16
    v_bfe_u32 v173, v173, s39, 16
    v_bfe_u32 v174, v174, s39, 16
    v_bfe_u32 v175, v175, s39, 16
    v_mfma_f32_32x32x16_bf16 v[80:95], v[204:207], v[44:47], v[80:95]
    s_nop 0
    v_mfma_f32_32x32x16_bf16 v[64:79], v[172:175], v[44:47], v[64:79]
    s_waitcnt lgkmcnt(8)
    ds_read2st64_b32 v[188:189], v28 offset0:56 offset1:57
    ds_read2st64_b32 v[190:191], v28 offset0:58 offset1:59
    ds_read2st64_b32 v[220:221], v29 offset0:56 offset1:57
    ds_read2st64_b32 v[222:223], v29 offset0:58 offset1:59
    v_perm_b32 v208, v208, v208, s41
    v_xor_b32_e64 v208, s40, v208
    v_perm_b32 v209, v209, v209, s41
    v_xor_b32_e64 v209, s40, v209
    v_perm_b32 v210, v210, v210, s41
    v_xor_b32_e64 v210, s40, v210
    v_perm_b32 v211, v211, v211, s41
    v_xor_b32_e64 v211, s40, v211
    v_bfe_u32 v176, v176, s39, 16
    v_bfe_u32 v177, v177, s39, 16
    v_bfe_u32 v178, v178, s39, 16
    v_bfe_u32 v179, v179, s39, 16
    v_mfma_f32_32x32x16_bf16 v[80:95], v[208:211], v[48:51], v[80:95]
    s_nop 0
    v_mfma_f32_32x32x16_bf16 v[64:79], v[176:179], v[48:51], v[64:79]
    s_waitcnt lgkmcnt(8)
    v_perm_b32 v212, v212, v212, s41
    v_xor_b32_e64 v212, s40, v212
    v_perm_b32 v213, v213, v213, s41
    v_xor_b32_e64 v213, s40, v213
    v_perm_b32 v214, v214, v214, s41
    v_xor_b32_e64 v214, s40, v214
    v_perm_b32 v215, v215, v215, s41
    v_xor_b32_e64 v215, s40, v215
    v_bfe_u32 v180, v180, s39, 16
    v_bfe_u32 v181, v181, s39, 16
    v_bfe_u32 v182, v182, s39, 16
    v_bfe_u32 v183, v183, s39, 16
    v_mfma_f32_32x32x16_bf16 v[80:95], v[212:215], v[52:55], v[80:95]
    s_nop 0
    v_mfma_f32_32x32x16_bf16 v[64:79], v[180:183], v[52:55], v[64:79]
    s_waitcnt lgkmcnt(4)
    v_perm_b32 v216, v216, v216, s41
    v_xor_b32_e64 v216, s40, v216
    v_perm_b32 v217, v217, v217, s41
    v_xor_b32_e64 v217, s40, v217
    v_perm_b32 v218, v218, v218, s41
    v_xor_b32_e64 v218, s40, v218
    v_perm_b32 v219, v219, v219, s41
    v_xor_b32_e64 v219, s40, v219
    v_bfe_u32 v184, v184, s39, 16
    v_bfe_u32 v185, v185, s39, 16
    v_bfe_u32 v186, v186, s39, 16
    v_bfe_u32 v187, v187, s39, 16
    v_mfma_f32_32x32x16_bf16 v[80:95], v[216:219], v[56:59], v[80:95]
    s_nop 0
    v_mfma_f32_32x32x16_bf16 v[64:79], v[184:187], v[56:59], v[64:79]
    s_waitcnt lgkmcnt(0)
    v_perm_b32 v220, v220, v220, s41
    v_xor_b32_e64 v220, s40, v220
    v_perm_b32 v221, v221, v221, s41
    v_xor_b32_e64 v221, s40, v221
    v_perm_b32 v222, v222, v222, s41
    v_xor_b32_e64 v222, s40, v222
    v_perm_b32 v223, v223, v223, s41
    v_xor_b32_e64 v223, s40, v223
    v_bfe_u32 v188, v188, s39, 16
    v_bfe_u32 v189, v189, s39, 16
    v_bfe_u32 v190, v190, s39, 16
    v_bfe_u32 v191, v191, s39, 16
    v_mfma_f32_32x32x16_bf16 v[80:95], v[220:223], v[60:63], v[80:95]
    s_nop 0
    v_mfma_f32_32x32x16_bf16 v[64:79], v[188:191], v[60:63], v[64:79]
    s_branch L_B_gdone
L_B_redo:
    s_cmp_eq_u32 s80, 0
    s_cbranch_scc0 L_B_accept
    s_mov_b32 s80, 1
    s_waitcnt vmcnt(0) lgkmcnt(0)
    ds_read_b128 v[160:163], v4 offset:16384
    ds_read_b128 v[164:167], v4 offset:17408
    ds_read_b128 v[168:171], v4 offset:0
    ds_read_b128 v[172:175], v4 offset:1024
    ds_read_b128 v[176:179], v4 offset:40960
    ds_read_b128 v[180:183], v4 offset:41984
    ds_read_b128 v[184:187], v4 offset:24576
    ds_read_b128 v[188:191], v4 offset:25600
    s_waitcnt lgkmcnt(0)
    v_mfma_f32_32x32x16_bf16 v[64:79], v[160:163], v[248:251], 0
    v_mfma_f32_32x32x16_bf16 v[64:79], v[164:167], v[252:255], v[64:79]
    v_mfma_f32_32x32x16_bf16 v[80:95], v[168:171], v[248:251], 0
    v_mfma_f32_32x32x16_bf16 v[80:95], v[172:175], v[252:255], v[80:95]
    v_mov_b32 v8, 0xff800000
    v_mov_b32 v9, 0xff800000
    s_cmp_ge_u32 s54, 8
    s_cselect_b64 vcc, -1, 0
    s_nop 7
    v_cndmask_b32_e64 v80, v8, v80, vcc
    v_cndmask_b32 v64, v80, v64, s[4:5]
    v_cndmask_b32_e64 v81, v8, v81, vcc
    v_cndmask_b32 v65, v81, v65, s[6:7]
    v_cndmask_b32_e64 v82, v8, v82, vcc
    v_cndmask_b32 v66, v82, v66, s[8:9]
    v_cndmask_b32_e64 v83, v8, v83, vcc
    v_cndmask_b32 v67, v83, v67, s[10:11]
    v_cndmask_b32_e64 v84, v8, v84, vcc
    v_cndmask_b32 v68, v84, v68, s[12:13]
    v_cndmask_b32_e64 v85, v8, v85, vcc
    v_cndmask_b32 v69, v85, v69, s[14:15]
    v_cndmask_b32_e64 v86, v8, v86, vcc
    v_cndmask_b32 v70, v86, v70, s[16:17]
    v_cndmask_b32_e64 v87, v8, v87, vcc
    v_cndmask_b32 v71, v87, v71, s[18:19]
    v_cndmask_b32_e64 v88, v8, v88, vcc
    v_cndmask_b32 v72, v88, v72, s[56:57]
    v_cndmask_b32_e64 v89, v8, v89, vcc
    v_cndmask_b32 v73, v89, v73, s[58:59]
    v_cndmask_b32_e64 v90, v8, v90, vcc
    v_cndmask_b32 v74, v90, v74, s[60:61]
    v_cndmask_b32_e64 v91, v8, v91, vcc
    v_cndmask_b32 v75, v91, v75, s[62:63]
    v_cndmask_b32_e64 v92, v8, v92, vcc
    v_cndmask_b32 v76, v92, v76, s[64:65]
    v_cndmask_b32_e64 v93, v8, v93, vcc
    v_cndmask_b32 v77, v93, v77, s[66:67]
    v_cndmask_b32_e64 v94, v8, v94, vcc
    v_cndmask_b32 v78, v94, v78, s[68:69]
    v_cndmask_b32_e64 v95, v8, v95, vcc
    v_cndmask_b32 v79, v95, v79, s[70:71]
    v_max3_f32 v8, v8, v64, v65
    v_max3_f32 v9, v9, v66, v67
    v_max3_f32 v8, v8, v68, v69
    v_max3_f32 v9, v9, v70, v71
    v_max3_f32 v8, v8, v72, v73
    v_max3_f32 v9, v9, v74, v75
    v_max3_f32 v8, v8, v76, v77
    v_max3_f32 v9, v9, v78, v79
    s_mov_b32 s38, s55
    v_add_u32 v12, 14336, v4
L_B_fl0:
    s_sub_u32 s38, s38, 1
    s_cbranch_scc1 L_B_fm
    ds_read_b128 v[160:163], v12 offset:0
    ds_read_b128 v[164:167], v12 offset:1024
    s_waitcnt lgkmcnt(0)
    v_mfma_f32_32x32x16_bf16 v[80:95], v[160:163], v[248:251], 0
    v_mfma_f32_32x32x16_bf16 v[80:95], v[164:167], v[252:255], v[80:95]
    v_subrev_u32 v12, 2048, v12
    s_nop 10
    v_max3_f32 v8, v8, v80, v81
    v_max3_f32 v9, v9, v82, v83
    v_max3_f32 v8, v8, v84, v85
    v_max3_f32 v9, v9, v86, v87
    v_max3_f32 v8, v8, v88, v89
    v_max3_f32 v9, v9, v90, v91
    v_max3_f32 v8, v8, v92, v93
    v_max3_f32 v9, v9, v94, v95
    s_branch L_B_fl0
L_B_fm:
    v_max_f32 v10, v8, v9
    v_max_f32 v11, v8, v9
    s_nop 1
    v_permlane32_swap_b32 v10, v11
    v_min_f32 v112, -v10, -v11
    v_min_f32 v113, -v10, -v11
    v_min_f32 v114, -v10, -v11
    v_min_f32 v115, -v10, -v11
    v_min_f32 v116, -v10, -v11
    v_min_f32 v117, -v10, -v11
    v_min_f32 v118, -v10, -v11
    v_min_f32 v119, -v10, -v11
    v_min_f32 v120, -v10, -v11
    v_min_f32 v121, -v10, -v11
    v_min_f32 v122, -v10, -v11
    v_min_f32 v123, -v10, -v11
    v_min_f32 v124, -v10, -v11
    v_min_f32 v125, -v10, -v11
    v_min_f32 v126, -v10, -v11
    v_min_f32 v127, -v10, -v11
    v_add_f32 v64, v64, v112
    v_add_f32 v65, v65, v112
    v_add_f32 v66, v66, v112
    v_add_f32 v67, v67, v112
    v_add_f32 v68, v68, v112
    v_add_f32 v69, v69, v112
    v_add_f32 v70, v70, v112
    v_add_f32 v71, v71, v112
    v_add_f32 v72, v72, v112
    v_add_f32 v73, v73, v112
    v_add_f32 v74, v74, v112
    v_add_f32 v75, v75, v112
    v_add_f32 v76, v76, v112
    v_add_f32 v77, v77, v112
    v_add_f32 v78, v78, v112
    v_add_f32 v79, v79, v112
    v_exp_f32 v64, v64
    v_exp_f32 v65, v65
    v_exp_f32 v66, v66
    v_exp_f32 v67, v67
    v_exp_f32 v68, v68
    v_exp_f32 v69, v69
    v_exp_f32 v70, v70
    v_exp_f32 v71, v71
    v_exp_f32 v72, v72
    v_exp_f32 v73, v73
    v_exp_f32 v74, v74
    v_exp_f32 v75, v75
    v_exp_f32 v76, v76
    v_exp_f32 v77, v77
    v_exp_f32 v78, v78
    v_exp_f32 v79, v79
    v_cvt_pk_bf16_f32 v152, v64, v65
    v_cvt_pk_bf16_f32 v153, v66, v67
    v_cvt_pk_bf16_f32 v154, v68, v69
    v_cvt_pk_bf16_f32 v155, v70, v71
    v_cvt_pk_bf16_f32 v156, v72, v73
    v_cvt_pk_bf16_f32 v157, v74, v75
    v_cvt_pk_bf16_f32 v158, v76, v77
    v_cvt_pk_bf16_f32 v159, v78, v79
    v_and_b32 v144, v240, v152
    v_xor_b32 v152, v144, v152
    v_and_b32 v145, v241, v153
    v_xor_b32 v153, v145, v153
    v_and_b32 v146, v242, v154
    v_xor_b32 v154, v146, v154
    v_and_b32 v147, v243, v155
    v_xor_b32 v155, v147, v155
    v_and_b32 v148, v244, v156
    v_xor_b32 v156, v148, v156
    v_and_b32 v149, v245, v157
    v_xor_b32 v157, v149, v157
    v_and_b32 v150, v246, v158
    v_xor_b32 v158, v150, v158
    v_and_b32 v151, v247, v159
    v_xor_b32 v159, v151, v159
    v_mfma_f32_32x32x16_bf16 v[128:143], v[176:179], v[144:147], 0
    v_mfma_f32_32x32x16_bf16 v[128:143], v[180:183], v[148:151], v[128:143]
    v_mfma_f32_32x32x16_bf16 v[128:143], v[184:187], v[152:155], v[128:143]
    v_mfma_f32_32x32x16_bf16 v[128:143], v[188:191], v[156:159], v[128:143]
    s_mov_b32 s38, s55
    v_add_u32 v12, 14336, v4
L_B_fl1:
    s_sub_u32 s38, s38, 1
    s_cbranch_scc1 L_B_p2done
    ds_read_b128 v[160:163], v12 offset:0
    ds_read_b128 v[164:167], v12 offset:1024
    ds_read_b128 v[168:171], v12 offset:24576
    ds_read_b128 v[172:175], v12 offset:25600
    s_waitcnt lgkmcnt(0)
    v_mfma_f32_32x32x16_bf16 v[80:95], v[160:163], v[248:251], v[112:127]
    v_mfma_f32_32x32x16_bf16 v[80:95], v[164:167], v[252:255], v[80:95]
    v_subrev_u32 v12, 2048, v12
    s_nop 10
    v_exp_f32 v80, v80
    v_exp_f32 v81, v81
    v_exp_f32 v82, v82
    v_exp_f32 v83, v83
    v_exp_f32 v84, v84
    v_exp_f32 v85, v85
    v_exp_f32 v86, v86
    v_exp_f32 v87, v87
    v_exp_f32 v88, v88
    v_exp_f32 v89, v89
    v_exp_f32 v90, v90
    v_exp_f32 v91, v91
    v_exp_f32 v92, v92
    v_exp_f32 v93, v93
    v_exp_f32 v94, v94
    v_exp_f32_e64 v95, v95
    v_cvt_pk_bf16_f32 v144, v80, v81
    v_cvt_pk_bf16_f32 v145, v82, v83
    v_cvt_pk_bf16_f32 v146, v84, v85
    v_cvt_pk_bf16_f32 v147, v86, v87
    v_cvt_pk_bf16_f32 v148, v88, v89
    v_cvt_pk_bf16_f32 v149, v90, v91
    v_cvt_pk_bf16_f32 v150, v92, v93
    v_cvt_pk_bf16_f32 v151, v94, v95
    v_mfma_f32_32x32x16_bf16 v[128:143], v[168:171], v[144:147], v[128:143]
    s_nop 0
    v_mfma_f32_32x32x16_bf16 v[128:143], v[172:175], v[148:151], v[128:143]
    s_branch L_B_fl1
L_A2:
    v_lshlrev_b32_e64 v15, 2, v0
    v_add_u32 v15, 159744, v15
    v_mov_b32_e64 v28, 0
    ds_write_b32 v15, v28
    s_mov_b32 s0, 1
    s_add_u32 s46, s24, 1835008
    s_addc_u32 s47, s25, 0
    s_mov_b32 s28, s20
    s_mov_b32 s29, s21
    s_mov_b32 s30, 3670016
    s_mov_b32 s31, 0x20000
    s_lshl2_add_u32 s75, s32, s38
    s_add_u32 s76, s36, 1
    s_bfe_u32 s11, s76, 0x10001
    s_and_b32 s76, s76, 4
    s_add_u32 s81, s76, s37
    s_bitcmp1_b32 0x2a54, s35
    s_cselect_b32 s15, 1, 0
    s_bitcmp1_b32 0xaad4, s35
    s_cselect_b32 s77, 0, 1
    v_and_b32 v2, 15, v0
    v_and_b32 v16, 3, v0
    s_mov_b32 s60, s4
    s_mov_b32 s61, s5
    s_mov_b32 s62, 1835008
    s_mov_b32 s63, 0x20000
    v_mul_u32_u24 v22, 57344, v3
    v_add_u32_e64 v22, v22, v6
    s_and_b32 s39, s37, 1
    s_lshl_b32 s39, s39, 6
    v_xor_b32 v22, s39, v22
    s_lshl_b32 s39, s37, 9
    s_add_u32 s39, s39, s11
    s_lshl1_add_u32 s39, s75, s39
    s_mul_i32 s80, s39, 896
    v_lshlrev_b32_e64 v19, 2, v16
    v_add_u32 v19, 159760, v19
    s_lshl2_add_u32 s38, s37, 159776
    v_mov_b32 v21, s38
    v_lshrrev_b32 v15, 2, v0
    v_mul_u32_u24 v51, 2688, v15
    v_lshl_add_u32 v51, v16, 4, v51
    s_mul_i32 s39, s35, 7
    s_lshr_b32 s39, s39, 1
    s_lshl4_add_u32 s74, s39, s74
    s_lshl_b32 s12, s37, 10
    v_mov_b32 v48, 1
    v_mov_b32 v50, 3
    v_bfe_u32 v15, v0, 1, 3
    v_xor_b32 v15, v15, v4
    v_lshlrev_b32 v15, 4, v15
    v_lshl_add_u32 v15, v2, 7, v15
    v_add_u32 v24, 73728, v15
    v_xor_b32 v25, 64, v24
    s_mul_i32 s66, s37, 3
    s_lshl2_add_u32 s67, s34, s66
    s_lshl_b32 s66, s66, 11
    s_mul_i32 s38, s35, 7
    s_lshr_b32 s64, s38, 1
    s_lshl_b32 s64, s64, 9
    s_lshl_b32 s65, s38, 6
    s_add_u32 s65, s65, 2097152
    s_lshl4_add_u32 s7, s34, s35
    s_lshl2_add_u32 s7, s7, s37
    s_lshl_b32 s7, s7, 6
    s_max_u32 s8, s67, 5
    s_sub_u32 s8, s8, 5
    s_min_u32 s8, s8, 3
    s_add_u32 s38, s15, 1
    s_lshl_b32 s8, s8, s38
    v_lshlrev_b32 v18, 4, v0
    v_lshrrev_b32 v31, 5, v0
    v_mul_u32_u24 v60, 6656, v31
    v_add_u32_e64 v60, v60, v18
    v_add_u32 v61, 13312, v60
    v_mov_b32_e64 v62, 2
    v_mul_u32_u24 v55, 229376, v4
    s_mul_i32 s78, s75, 3584
    v_lshl_add_u32 v55, v2, 3, v55
    s_mul_i32 s39, s11, 14
    s_add_u32 s39, s39, s81
    s_lshl_b32 s39, s39, 7
    s_add_u32 s78, s78, s39
    s_lshl1_add_u32 s10, s81, s11
    s_lshl_b32 s10, s10, 7
    s_lshl_b32 s39, s81, 5
    s_add_u32 s39, s39, 0
    v_mad_u32_u24 v14, v2, 2, s39
    v_cmp_lt_u32 vcc, 224, v14
    v_cvt_f32_u32_e64 v14, v14
    v_cvt_f32_u32 v17, v4
    s_mov_b64 s[82:83], vcc
    v_mul_f32 v28, 0x3b124925, v14
    v_mul_f32 v30, 0x3d924925, v14
    v_mov_b32 v29, 0x3e800000
    v_cndmask_b32 v29, 0, v29, vcc
    v_cos_f32 v30, v30
    v_mul_f32 v14, 0x41000000, v17
    v_fma_f32 v29, v14, v28, v29
    v_add_f32_e64 v30, v30, v30
    v_fmamk_f32 v96, v28, 0x00000000, v29
    v_fmamk_f32 v97, v28, 0x3f800000, v29
    v_fmamk_f32 v98, v28, 0x40000000, v29
    v_fmamk_f32 v99, v28, 0x40400000, v29
    v_fmamk_f32 v100, v28, 0x40800000, v29
    v_fmamk_f32 v101, v28, 0x40a00000, v29
    v_fmamk_f32 v102, v28, 0x40c00000, v29
    v_fmamk_f32 v103, v28, 0x40e00000, v29
    v_cos_f32 v96, v96
    v_cos_f32 v97, v97
    v_cos_f32 v98, v98
    v_cos_f32 v99, v99
    v_cos_f32 v100, v100
    v_cos_f32 v101, v101
    v_cos_f32 v102, v102
    v_cos_f32 v103, v103
    v_fmamk_f32 v104, v28, 0x42000000, v29
    v_fmamk_f32 v105, v28, 0x42040000, v29
    v_fmamk_f32 v106, v28, 0x42080000, v29
    v_fmamk_f32 v107, v28, 0x420c0000, v29
    v_fmamk_f32 v108, v28, 0x42100000, v29
    v_fmamk_f32 v109, v28, 0x42140000, v29
    v_fmamk_f32 v110, v28, 0x42180000, v29
    v_fmamk_f32 v111, v28, 0x421c0000, v29
    v_cos_f32 v104, v104
    v_cos_f32 v105, v105
    v_cos_f32 v106, v106
    v_cos_f32 v107, v107
    v_cos_f32 v108, v108
    v_cos_f32 v109, v109
    v_cos_f32 v110, v110
    v_cos_f32 v111, v111
    v_cvt_pk_bf16_f32 v128, v96, v97
    v_cvt_pk_bf16_f32 v129, v98, v99
    v_cvt_pk_bf16_f32 v130, v100, v101
    v_cvt_pk_bf16_f32 v131, v102, v103
    v_pk_fma_f32 v[96:97], v[104:105], v[30:31], v[96:97] op_sel_hi:[1,0,1] neg_lo:[0,0,1] neg_hi:[0,0,1]
    v_pk_fma_f32 v[98:99], v[106:107], v[30:31], v[98:99] op_sel_hi:[1,0,1] neg_lo:[0,0,1] neg_hi:[0,0,1]
    v_pk_fma_f32 v[100:101], v[108:109], v[30:31], v[100:101] op_sel_hi:[1,0,1] neg_lo:[0,0,1] neg_hi:[0,0,1]
    v_pk_fma_f32 v[102:103], v[110:111], v[30:31], v[102:103] op_sel_hi:[1,0,1] neg_lo:[0,0,1] neg_hi:[0,0,1]
    v_cvt_pk_bf16_f32 v132, v104, v105
    v_cvt_pk_bf16_f32 v133, v106, v107
    v_cvt_pk_bf16_f32 v134, v108, v109
    v_cvt_pk_bf16_f32 v135, v110, v111
    v_pk_fma_f32 v[104:105], v[96:97], v[30:31], v[104:105] op_sel_hi:[1,0,1] neg_lo:[0,0,1] neg_hi:[0,0,1]
    v_pk_fma_f32 v[106:107], v[98:99], v[30:31], v[106:107] op_sel_hi:[1,0,1] neg_lo:[0,0,1] neg_hi:[0,0,1]
    v_pk_fma_f32 v[108:109], v[100:101], v[30:31], v[108:109] op_sel_hi:[1,0,1] neg_lo:[0,0,1] neg_hi:[0,0,1]
    v_pk_fma_f32 v[110:111], v[102:103], v[30:31], v[110:111] op_sel_hi:[1,0,1] neg_lo:[0,0,1] neg_hi:[0,0,1]
    v_cvt_pk_bf16_f32 v136, v96, v97
    v_cvt_pk_bf16_f32 v137, v98, v99
    v_cvt_pk_bf16_f32 v138, v100, v101
    v_cvt_pk_bf16_f32 v139, v102, v103
    v_pk_fma_f32 v[96:97], v[104:105], v[30:31], v[96:97] op_sel_hi:[1,0,1] neg_lo:[0,0,1] neg_hi:[0,0,1]
    v_pk_fma_f32 v[98:99], v[106:107], v[30:31], v[98:99] op_sel_hi:[1,0,1] neg_lo:[0,0,1] neg_hi:[0,0,1]
    v_pk_fma_f32 v[100:101], v[108:109], v[30:31], v[100:101] op_sel_hi:[1,0,1] neg_lo:[0,0,1] neg_hi:[0,0,1]
    v_pk_fma_f32 v[102:103], v[110:111], v[30:31], v[102:103] op_sel_hi:[1,0,1] neg_lo:[0,0,1] neg_hi:[0,0,1]
    v_cvt_pk_bf16_f32 v140, v104, v105
    v_cvt_pk_bf16_f32 v141, v106, v107
    v_cvt_pk_bf16_f32 v142, v108, v109
    v_cvt_pk_bf16_f32 v143, v110, v111
    v_pk_fma_f32 v[104:105], v[96:97], v[30:31], v[104:105] op_sel_hi:[1,0,1] neg_lo:[0,0,1] neg_hi:[0,0,1]
    v_pk_fma_f32 v[106:107], v[98:99], v[30:31], v[106:107] op_sel_hi:[1,0,1] neg_lo:[0,0,1] neg_hi:[0,0,1]
    v_pk_fma_f32 v[108:109], v[100:101], v[30:31], v[108:109] op_sel_hi:[1,0,1] neg_lo:[0,0,1] neg_hi:[0,0,1]
    v_pk_fma_f32 v[110:111], v[102:103], v[30:31], v[110:111] op_sel_hi:[1,0,1] neg_lo:[0,0,1] neg_hi:[0,0,1]
    v_cvt_pk_bf16_f32 v144, v96, v97
    v_cvt_pk_bf16_f32 v145, v98, v99
    v_cvt_pk_bf16_f32 v146, v100, v101
    v_cvt_pk_bf16_f32 v147, v102, v103
    v_pk_fma_f32 v[96:97], v[104:105], v[30:31], v[96:97] op_sel_hi:[1,0,1] neg_lo:[0,0,1] neg_hi:[0,0,1]
    v_pk_fma_f32 v[98:99], v[106:107], v[30:31], v[98:99] op_sel_hi:[1,0,1] neg_lo:[0,0,1] neg_hi:[0,0,1]
    v_pk_fma_f32 v[100:101], v[108:109], v[30:31], v[100:101] op_sel_hi:[1,0,1] neg_lo:[0,0,1] neg_hi:[0,0,1]
    v_pk_fma_f32 v[102:103], v[110:111], v[30:31], v[102:103] op_sel_hi:[1,0,1] neg_lo:[0,0,1] neg_hi:[0,0,1]
    v_cvt_pk_bf16_f32 v148, v104, v105
    v_cvt_pk_bf16_f32 v149, v106, v107
    v_cvt_pk_bf16_f32 v150, v108, v109
    v_cvt_pk_bf16_f32 v151, v110, v111
    v_cvt_pk_bf16_f32 v152, v96, v97
    v_cvt_pk_bf16_f32 v153, v98, v99
    v_cvt_pk_bf16_f32 v154, v100, v101
    v_cvt_pk_bf16_f32 v155, v102, v103
    s_lshl_b32 s39, s81, 5
    s_add_u32 s39, s39, 1
    v_mad_u32_u24 v14, v2, 2, s39
    v_cmp_lt_u32 vcc, 224, v14
    v_cvt_f32_u32_e64 v14, v14
    v_cvt_f32_u32 v17, v4
    s_mov_b64 s[16:17], vcc
    v_mul_f32 v28, 0x3b124925, v14
    v_mul_f32 v30, 0x3d924925, v14
    v_mov_b32 v29, 0x3e800000
    v_cndmask_b32 v29, 0, v29, vcc
    v_cos_f32 v30, v30
    v_mul_f32 v14, 0x41000000, v17
    v_fma_f32 v29, v14, v28, v29
    v_add_f32_e64 v30, v30, v30
    v_fmamk_f32 v96, v28, 0x00000000, v29
    v_fmamk_f32 v97, v28, 0x3f800000, v29
    v_fmamk_f32 v98, v28, 0x40000000, v29
    v_fmamk_f32 v99, v28, 0x40400000, v29
    v_fmamk_f32 v100, v28, 0x40800000, v29
    v_fmamk_f32 v101, v28, 0x40a00000, v29
    v_fmamk_f32 v102, v28, 0x40c00000, v29
    v_fmamk_f32 v103, v28, 0x40e00000, v29
    v_cos_f32 v96, v96
    v_cos_f32 v97, v97
    v_cos_f32 v98, v98
    v_cos_f32 v99, v99
    v_cos_f32 v100, v100
    v_cos_f32 v101, v101
    v_cos_f32 v102, v102
    v_cos_f32 v103, v103
    v_fmamk_f32 v104, v28, 0x42000000, v29
    v_fmamk_f32 v105, v28, 0x42040000, v29
    v_fmamk_f32 v106, v28, 0x42080000, v29
    v_fmamk_f32 v107, v28, 0x420c0000, v29
    v_fmamk_f32 v108, v28, 0x42100000, v29
    v_fmamk_f32 v109, v28, 0x42140000, v29
    v_fmamk_f32 v110, v28, 0x42180000, v29
    v_fmamk_f32 v111, v28, 0x421c0000, v29
    v_cos_f32 v104, v104
    v_cos_f32 v105, v105
    v_cos_f32 v106, v106
    v_cos_f32 v107, v107
    v_cos_f32 v108, v108
    v_cos_f32 v109, v109
    v_cos_f32 v110, v110
    v_cos_f32 v111, v111
    v_cvt_pk_bf16_f32 v156, v96, v97
    v_cvt_pk_bf16_f32 v157, v98, v99
    v_cvt_pk_bf16_f32 v158, v100, v101
    v_cvt_pk_bf16_f32 v159, v102, v103
    v_pk_fma_f32 v[96:97], v[104:105], v[30:31], v[96:97] op_sel_hi:[1,0,1] neg_lo:[0,0,1] neg_hi:[0,0,1]
    v_pk_fma_f32 v[98:99], v[106:107], v[30:31], v[98:99] op_sel_hi:[1,0,1] neg_lo:[0,0,1] neg_hi:[0,0,1]
    v_pk_fma_f32 v[100:101], v[108:109], v[30:31], v[100:101] op_sel_hi:[1,0,1] neg_lo:[0,0,1] neg_hi:[0,0,1]
    v_pk_fma_f32 v[102:103], v[110:111], v[30:31], v[102:103] op_sel_hi:[1,0,1] neg_lo:[0,0,1] neg_hi:[0,0,1]
    v_cvt_pk_bf16_f32 v160, v104, v105
    v_cvt_pk_bf16_f32 v161, v106, v107
    v_cvt_pk_bf16_f32 v162, v108, v109
    v_cvt_pk_bf16_f32 v163, v110, v111
    v_pk_fma_f32 v[104:105], v[96:97], v[30:31], v[104:105] op_sel_hi:[1,0,1] neg_lo:[0,0,1] neg_hi:[0,0,1]
    v_pk_fma_f32 v[106:107], v[98:99], v[30:31], v[106:107] op_sel_hi:[1,0,1] neg_lo:[0,0,1] neg_hi:[0,0,1]
    v_pk_fma_f32 v[108:109], v[100:101], v[30:31], v[108:109] op_sel_hi:[1,0,1] neg_lo:[0,0,1] neg_hi:[0,0,1]
    v_pk_fma_f32 v[110:111], v[102:103], v[30:31], v[110:111] op_sel_hi:[1,0,1] neg_lo:[0,0,1] neg_hi:[0,0,1]
    v_cvt_pk_bf16_f32 v164, v96, v97
    v_cvt_pk_bf16_f32 v165, v98, v99
    v_cvt_pk_bf16_f32 v166, v100, v101
    v_cvt_pk_bf16_f32 v167, v102, v103
    v_pk_fma_f32 v[96:97], v[104:105], v[30:31], v[96:97] op_sel_hi:[1,0,1] neg_lo:[0,0,1] neg_hi:[0,0,1]
    v_pk_fma_f32 v[98:99], v[106:107], v[30:31], v[98:99] op_sel_hi:[1,0,1] neg_lo:[0,0,1] neg_hi:[0,0,1]
    v_pk_fma_f32 v[100:101], v[108:109], v[30:31], v[100:101] op_sel_hi:[1,0,1] neg_lo:[0,0,1] neg_hi:[0,0,1]
    v_pk_fma_f32 v[102:103], v[110:111], v[30:31], v[102:103] op_sel_hi:[1,0,1] neg_lo:[0,0,1] neg_hi:[0,0,1]
    v_cvt_pk_bf16_f32 v168, v104, v105
    v_cvt_pk_bf16_f32 v169, v106, v107
    v_cvt_pk_bf16_f32 v170, v108, v109
    v_cvt_pk_bf16_f32 v171, v110, v111
    v_pk_fma_f32 v[104:105], v[96:97], v[30:31], v[104:105] op_sel_hi:[1,0,1] neg_lo:[0,0,1] neg_hi:[0,0,1]
    v_pk_fma_f32 v[106:107], v[98:99], v[30:31], v[106:107] op_sel_hi:[1,0,1] neg_lo:[0,0,1] neg_hi:[0,0,1]
    v_pk_fma_f32 v[108:109], v[100:101], v[30:31], v[108:109] op_sel_hi:[1,0,1] neg_lo:[0,0,1] neg_hi:[0,0,1]
    v_pk_fma_f32 v[110:111], v[102:103], v[30:31], v[110:111] op_sel_hi:[1,0,1] neg_lo:[0,0,1] neg_hi:[0,0,1]
    v_cvt_pk_bf16_f32 v172, v96, v97
    v_cvt_pk_bf16_f32 v173, v98, v99
    v_cvt_pk_bf16_f32 v174, v100, v101
    v_cvt_pk_bf16_f32 v175, v102, v103
    v_pk_fma_f32 v[96:97], v[104:105], v[30:31], v[96:97] op_sel_hi:[1,0,1] neg_lo:[0,0,1] neg_hi:[0,0,1]
    v_pk_fma_f32 v[98:99], v[106:107], v[30:31], v[98:99] op_sel_hi:[1,0,1] neg_lo:[0,0,1] neg_hi:[0,0,1]
    v_pk_fma_f32 v[100:101], v[108:109], v[30:31], v[100:101] op_sel_hi:[1,0,1] neg_lo:[0,0,1] neg_hi:[0,0,1]
    s_add_u32 m0, s72, 16384
    s_bfe_u32 s45, s1, 0x30008
    s_mul_i32 s45, s45, 172032
    s_add_u32 s45, s45, s55
    buffer_load_dwordx4 v12, s[56:59], s45 offen offset:0 lds
    buffer_load_dwordx4 v13, s[56:59], s45 offen offset:1024 lds
    s_add_u32 m0, s53, 32768
    s_bfe_u32 s45, s1, 0x30008
    s_mul_i32 s45, s45, 128
    s_add_u32 s45, s45, s52
    buffer_load_dwordx4 v8, s[48:51], s45 offen offset:0 lds
    buffer_load_dwordx4 v9, s[48:51], s45 offen offset:1024 lds
    buffer_load_dwordx4 v10, s[48:51], s45 offen offset:2048 lds
    buffer_load_dwordx4 v11, s[48:51], s45 offen offset:3072 lds
    s_waitcnt lgkmcnt(0)
    s_waitcnt vmcnt(8)
    s_barrier
    s_add_u32 m0, s72, 24576
    s_bfe_u32 s45, s1, 0x3000c
    s_mul_i32 s45, s45, 172032
    s_add_u32 s45, s45, s55
    buffer_load_dwordx4 v12, s[56:59], s45 offen offset:0 lds
    buffer_load_dwordx4 v13, s[56:59], s45 offen offset:1024 lds
    s_add_u32 m0, s53, 49152
    s_bfe_u32 s45, s1, 0x3000c
    s_mul_i32 s45, s45, 128
    s_add_u32 s45, s45, s52
    buffer_load_dwordx4 v8, s[48:51], s45 offen offset:0 lds
    buffer_load_dwordx4 v9, s[48:51], s45 offen offset:1024 lds
    buffer_load_dwordx4 v10, s[48:51], s45 offen offset:2048 lds
    buffer_load_dwordx4 v11, s[48:51], s45 offen offset:3072 lds
    s_waitcnt vmcnt(12)
    s_barrier
    s_add_u32 m0, s72, 32768
    s_bfe_u32 s45, s1, 0x30010
    s_mul_i32 s45, s45, 172032
    s_add_u32 s45, s45, s55
    buffer_load_dwordx4 v12, s[56:59], s45 offen offset:0 lds
    buffer_load_dwordx4 v13, s[56:59], s45 offen offset:1024 lds
    s_add_u32 m0, s53, 65536
    s_bfe_u32 s45, s1, 0x30010
    s_mul_i32 s45, s45, 128
    s_add_u32 s45, s45, s52
    buffer_load_dwordx4 v8, s[48:51], s45 offen offset:0 lds
    buffer_load_dwordx4 v9, s[48:51], s45 offen offset:1024 lds
    buffer_load_dwordx4 v10, s[48:51], s45 offen offset:2048 lds
    buffer_load_dwordx4 v11, s[48:51], s45 offen offset:3072 lds
    s_waitcnt vmcnt(12)
    s_barrier
    s_add_u32 m0, s72, 40960
    s_bfe_u32 s45, s1, 0x30014
    s_mul_i32 s45, s45, 172032
    s_add_u32 s45, s45, s55
    buffer_load_dwordx4 v12, s[56:59], s45 offen offset:0 lds
    buffer_load_dwordx4 v13, s[56:59], s45 offen offset:1024 lds
    s_add_u32 m0, s53, 81920
    s_bfe_u32 s45, s1, 0x30014
    s_mul_i32 s45, s45, 128
    s_add_u32 s45, s45, s52
    buffer_load_dwordx4 v8, s[48:51], s45 offen offset:0 lds
    buffer_load_dwordx4 v9, s[48:51], s45 offen offset:1024 lds
    buffer_load_dwordx4 v10, s[48:51], s45 offen offset:2048 lds
    buffer_load_dwordx4 v11, s[48:51], s45 offen offset:3072 lds
    s_waitcnt vmcnt(12)
    s_barrier
    s_add_u32 m0, s72, 49152
    s_bfe_u32 s45, s1, 0x30018
    s_mul_i32 s45, s45, 172032
    s_add_u32 s45, s45, s55
    buffer_load_dwordx4 v12, s[56:59], s45 offen offset:0 lds
    buffer_load_dwordx4 v13, s[56:59], s45 offen offset:1024 lds
    s_add_u32 m0, s53, 0
    s_bfe_u32 s45, s1, 0x30018
    s_mul_i32 s45, s45, 128
    s_add_u32 s45, s45, s52
    buffer_load_dwordx4 v8, s[48:51], s45 offen offset:0 lds
    buffer_load_dwordx4 v9, s[48:51], s45 offen offset:1024 lds
    buffer_load_dwordx4 v10, s[48:51], s45 offen offset:2048 lds
    buffer_load_dwordx4 v11, s[48:51], s45 offen offset:3072 lds
    v_pk_fma_f32 v[102:103], v[110:111], v[30:31], v[102:103] op_sel_hi:[1,0,1] neg_lo:[0,0,1] neg_hi:[0,0,1]
    v_cvt_pk_bf16_f32 v176, v104, v105
    v_cvt_pk_bf16_f32 v177, v106, v107
    v_cvt_pk_bf16_f32 v178, v108, v109
    v_cvt_pk_bf16_f32 v179, v110, v111
    v_cvt_pk_bf16_f32 v180, v96, v97
    v_cvt_pk_bf16_f32 v181, v98, v99
    v_cvt_pk_bf16_f32 v182, v100, v101
    v_cvt_pk_bf16_f32 v183, v102, v103
    s_mov_b32 s39, 0x80008000
    v_xor_b32 v184, s39, v156
    v_xor_b32 v185, s39, v157
    v_xor_b32 v186, s39, v158
    v_xor_b32 v187, s39, v159
    v_xor_b32 v188, s39, v160
    v_xor_b32 v189, s39, v161
    v_xor_b32 v190, s39, v162
    v_xor_b32 v191, s39, v163
    v_xor_b32 v192, s39, v164
    v_xor_b32 v193, s39, v165
    v_xor_b32 v194, s39, v166
    v_xor_b32 v195, s39, v167
    v_xor_b32 v196, s39, v168
    v_xor_b32 v197, s39, v169
    v_xor_b32 v198, s39, v170
    s_waitcnt vmcnt(12)
    s_barrier
    v_xor_b32 v199, s39, v171
    v_xor_b32 v200, s39, v172
    v_xor_b32 v201, s39, v173
    v_xor_b32 v202, s39, v174
    v_xor_b32 v203, s39, v175
    v_xor_b32 v204, s39, v176
    v_xor_b32 v205, s39, v177
    v_xor_b32 v206, s39, v178
    v_xor_b32 v207, s39, v179
    v_xor_b32 v208, s39, v180
    v_xor_b32 v209, s39, v181
    v_xor_b32 v210, s39, v182
    v_xor_b32 v211, s39, v183
    v_and_b32 v14, 1, v0
    v_cvt_f32_u32 v14, v14
    v_mul_f32 v14, 0xbe800000, v14
    v_cmp_eq_u32 vcc, 1, v2
    v_lshrrev_b32 v15, 1, v2
    v_cvt_f32_u32 v28, v15
    v_and_b32 v15, 1, v15
    v_mul_u32_u24 v15, 0x8000, v15
    v_lshl_add_u32 v15, v15, 16, v15
    v_mul_f32 v28, 0x3d000000, v28
    v_cvt_f32_u32_e64 v17, v4
    v_mul_f32 v17, 4.0, v17
    s_waitcnt vmcnt(4)
    s_barrier
    s_cmp_eq_u32 s77, 0
    s_cbranch_scc1 L_A_S
    s_add_u32 m0, s12, 73728
    s_add_u32 s45, s80, 0
    buffer_load_dwordx4 v22, s[60:63], s45 offen lds
    s_add_u32 m0, s12, 77824
    s_add_u32 s45, s80, 128
    buffer_load_dwordx4 v22, s[60:63], s45 offen lds
    s_add_u32 m0, s12, 81920
    s_add_u32 s45, s80, 256
    buffer_load_dwordx4 v22, s[60:63], s45 offen lds
    s_waitcnt vmcnt(3)
    s_barrier
    s_add_u32 m0, s12, 86016
    s_add_u32 s45, s80, 384
    buffer_load_dwordx4 v22, s[60:63], s45 offen lds
    s_add_u32 m0, s12, 90112
    s_add_u32 s45, s80, 512
    buffer_load_dwordx4 v22, s[60:63], s45 offen lds
    s_add_u32 m0, s12, 94208
    s_add_u32 s45, s80, 640
    buffer_load_dwordx4 v22, s[60:63], s45 offen lds
    s_add_u32 m0, s12, 98304
    s_add_u32 s45, s80, 768
    buffer_load_dwordx4 v22, s[60:63], s45 offen lds
    v_add_f32 v29, 0x3e800000, v28
    v_fma_f32 v30, v17, v29, v14
    v_add_f32_e64 v33, v29, v30
    v_fma_f32 v34, v29, 2.0, v30
    v_fma_f32 v35, v29, 2.0, v33
    v_cos_f32 v32, v30
    v_cos_f32 v33, v33
    v_cos_f32 v34, v34
    v_cos_f32 v35, v35
    v_cvt_pk_bf16_f32 v44, v32, v33
    v_cvt_pk_bf16_f32 v45, v34, v35
    v_xor_b32 v46, v15, v44
    v_xor_b32 v47, v15, v45
    v_cndmask_b32 v29, v28, 0.5, vcc
    v_cndmask_b32 v14, v14, 0, vcc
    v_fma_f32 v30, v17, v29, v14
    v_add_f32_e64 v33, v29, v30
    v_fma_f32 v34, v29, 2.0, v30
    v_fma_f32 v35, v29, 2.0, v33
    v_cos_f32 v32, v30
    v_cos_f32 v33, v33
    v_cos_f32 v34, v34
    v_cos_f32 v35, v35
    v_cvt_pk_bf16_f32 v40, v32, v33
    v_cvt_pk_bf16_f32 v41, v34, v35
    v_xor_b32_e64 v42, v15, v40
    v_xor_b32 v43, v15, v41
    ds_write_b32 v21, v62 offset:16
    s_waitcnt vmcnt(0)
    ds_write_b32 v21, v48
    s_mov_b32 s42, 0x100000
spin_28:
    ds_read_b32 v30, v19 offset:16
    s_waitcnt lgkmcnt(0)
    v_cmp_gt_u32 vcc, 1, v30
    s_sub_u32 s42, s42, 1
    s_cbranch_vccz spinx_29
    s_cbranch_scc0 spin_28
spinx_29:
    s_setprio 2
    ds_read_b128 v[64:67], v24 offset:0
    ds_read_b128 v[68:71], v24 offset:2048
    ds_read_b128 v[72:75], v25 offset:0
    ds_read_b128 v[76:79], v25 offset:2048
    ds_read_b128 v[80:83], v24 offset:4096
    ds_read_b128 v[84:87], v24 offset:6144
    ds_read_b128 v[88:91], v25 offset:4096
    ds_read_b128 v[92:95], v25 offset:6144
    ds_read_b128 v[96:99], v24 offset:8192
    ds_read_b128 v[100:103], v24 offset:10240
    ds_read_b128 v[104:107], v25 offset:8192
    ds_read_b128 v[108:111], v25 offset:10240
    s_waitcnt lgkmcnt(10)
    v_mfma_f32_16x16x32_bf16 v[212:215], v[64:67], v[128:131], 0
    v_mfma_f32_16x16x32_bf16 v[216:219], v[68:71], v[128:131], 0
    v_mfma_f32_16x16x32_bf16 v[220:223], v[64:67], v[156:159], 0
    v_mfma_f32_16x16x32_bf16 v[224:227], v[68:71], v[156:159], 0
    ds_read_b128 v[64:67], v24 offset:12288
    ds_read_b128 v[68:71], v24 offset:14336
    s_waitcnt lgkmcnt(10)
    v_mfma_f32_16x16x32_bf16 v[212:215], v[72:75], v[132:135], v[212:215]
    v_mfma_f32_16x16x32_bf16 v[216:219], v[76:79], v[132:135], v[216:219]
    v_mfma_f32_16x16x32_bf16 v[220:223], v[72:75], v[160:163], v[220:223]
    v_mfma_f32_16x16x32_bf16 v[224:227], v[76:79], v[160:163], v[224:227]
    ds_read_b128 v[72:75], v25 offset:12288
    ds_read_b128 v[76:79], v25 offset:14336
    s_waitcnt lgkmcnt(10)
    v_mfma_f32_16x16x32_bf16 v[212:215], v[80:83], v[136:139], v[212:215]
    v_mfma_f32_16x16x32_bf16 v[216:219], v[84:87], v[136:139], v[216:219]
    v_mfma_f32_16x16x32_bf16 v[220:223], v[80:83], v[164:167], v[220:223]
    v_mfma_f32_16x16x32_bf16 v[224:227], v[84:87], v[164:167], v[224:227]
    ds_read_b128 v[80:83], v24 offset:16384
    ds_read_b128 v[84:87], v24 offset:18432
    s_waitcnt lgkmcnt(10)
    v_mfma_f32_16x16x32_bf16 v[212:215], v[88:91], v[140:143], v[212:215]
    v_mfma_f32_16x16x32_bf16 v[216:219], v[92:95], v[140:143], v[216:219]
    v_mfma_f32_16x16x32_bf16 v[220:223], v[88:91], v[168:171], v[220:223]
    v_mfma_f32_16x16x32_bf16 v[224:227], v[92:95], v[168:171], v[224:227]
    ds_read_b128 v[88:91], v25 offset:16384
    ds_read_b128 v[92:95], v25 offset:18432
    s_waitcnt lgkmcnt(10)
    v_mfma_f32_16x16x32_bf16 v[212:215], v[96:99], v[144:147], v[212:215]
    v_mfma_f32_16x16x32_bf16 v[216:219], v[100:103], v[144:147], v[216:219]
    v_mfma_f32_16x16x32_bf16 v[220:223], v[96:99], v[172:175], v[220:223]
    v_mfma_f32_16x16x32_bf16 v[224:227], v[100:103], v[172:175], v[224:227]
    ds_read_b128 v[96:99], v24 offset:20480
    ds_read_b128 v[100:103], v24 offset:22528
    s_waitcnt lgkmcnt(10)
    v_mfma_f32_16x16x32_bf16 v[212:215], v[104:107], v[148:151], v[212:215]
    v_mfma_f32_16x16x32_bf16 v[216:219], v[108:111], v[148:151], v[216:219]
    v_mfma_f32_16x16x32_bf16 v[220:223], v[104:107], v[176:179], v[220:223]
    v_mfma_f32_16x16x32_bf16 v[224:227], v[108:111], v[176:179], v[224:227]
    ds_read_b128 v[104:107], v25 offset:20480
    ds_read_b128 v[108:111], v25 offset:22528
    s_waitcnt lgkmcnt(10)
    v_mfma_f32_16x16x32_bf16 v[212:215], v[64:67], v[152:155], v[212:215]
    v_mfma_f32_16x16x32_bf16 v[216:219], v[68:71], v[152:155], v[216:219]
    v_mfma_f32_16x16x32_bf16 v[220:223], v[64:67], v[180:183], v[220:223]
    v_mfma_f32_16x16x32_bf16 v[224:227], v[68:71], v[180:183], v[224:227]
    ds_read_b128 v[64:67], v24 offset:24576
    ds_read_b128 v[68:71], v24 offset:26624
    s_waitcnt lgkmcnt(10)
    v_mfma_f32_16x16x32_bf16 v[212:215], v[72:75], v[128:131], v[212:215]
    v_mfma_f32_16x16x32_bf16 v[216:219], v[76:79], v[128:131], v[216:219]
    v_mfma_f32_16x16x32_bf16 v[220:223], v[72:75], v[184:187], v[220:223]
    v_mfma_f32_16x16x32_bf16 v[224:227], v[76:79], v[184:187], v[224:227]
    ds_read_b128 v[72:75], v25 offset:24576
    ds_read_b128 v[76:79], v25 offset:26624
    s_waitcnt lgkmcnt(10)
    v_mfma_f32_16x16x32_bf16 v[212:215], v[80:83], v[132:135], v[212:215]
    v_mfma_f32_16x16x32_bf16 v[216:219], v[84:87], v[132:135], v[216:219]
    v_mfma_f32_16x16x32_bf16 v[220:223], v[80:83], v[188:191], v[220:223]
    v_mfma_f32_16x16x32_bf16 v[224:227], v[84:87], v[188:191], v[224:227]
    s_waitcnt lgkmcnt(8)
    v_mfma_f32_16x16x32_bf16 v[212:215], v[88:91], v[136:139], v[212:215]
    v_mfma_f32_16x16x32_bf16 v[216:219], v[92:95], v[136:139], v[216:219]
    v_mfma_f32_16x16x32_bf16 v[220:223], v[88:91], v[192:195], v[220:223]
    v_mfma_f32_16x16x32_bf16 v[224:227], v[92:95], v[192:195], v[224:227]
    s_waitcnt lgkmcnt(6)
    v_mfma_f32_16x16x32_bf16 v[212:215], v[96:99], v[140:143], v[212:215]
    v_mfma_f32_16x16x32_bf16 v[216:219], v[100:103], v[140:143], v[216:219]
    v_mfma_f32_16x16x32_bf16 v[220:223], v[96:99], v[196:199], v[220:223]
    v_mfma_f32_16x16x32_bf16 v[224:227], v[100:103], v[196:199], v[224:227]
    s_waitcnt lgkmcnt(4)
    v_mfma_f32_16x16x32_bf16 v[212:215], v[104:107], v[144:147], v[212:215]
    v_mfma_f32_16x16x32_bf16 v[216:219], v[108:111], v[144:147], v[216:219]
    v_mfma_f32_16x16x32_bf16 v[220:223], v[104:107], v[200:203], v[220:223]
    v_mfma_f32_16x16x32_bf16 v[224:227], v[108:111], v[200:203], v[224:227]
    s_waitcnt lgkmcnt(2)
    v_mfma_f32_16x16x32_bf16 v[212:215], v[64:67], v[148:151], v[212:215]
    v_mfma_f32_16x16x32_bf16 v[216:219], v[68:71], v[148:151], v[216:219]
    v_mfma_f32_16x16x32_bf16 v[220:223], v[64:67], v[204:207], v[220:223]
    v_mfma_f32_16x16x32_bf16 v[224:227], v[68:71], v[204:207], v[224:227]
    s_waitcnt lgkmcnt(0)
    v_mfma_f32_16x16x32_bf16 v[212:215], v[72:75], v[152:155], v[212:215]
    v_mfma_f32_16x16x32_bf16 v[216:219], v[76:79], v[152:155], v[216:219]
    v_mfma_f32_16x16x32_bf16 v[220:223], v[72:75], v[208:211], v[220:223]
    v_mfma_f32_16x16x32_bf16 v[224:227], v[76:79], v[208:211], v[224:227]
    s_setprio 2
    s_nop 3
    v_cvt_pk_bf16_f32 v64, v212, v213
    v_cvt_pk_bf16_f32 v65, v214, v215
    v_cvt_pk_bf16_f32 v66, v216, v217
    v_cvt_pk_bf16_f32 v67, v218, v219
    v_cvt_pk_bf16_f32 v68, v220, v221
    v_cvt_pk_bf16_f32 v69, v222, v223
    v_cvt_pk_bf16_f32 v70, v224, v225
    v_cvt_pk_bf16_f32 v71, v226, v227
    v_mfma_f32_16x16x32_bf16 v[128:131], v[40:43], v[64:67], 0
    s_nop 0
    v_mfma_f32_16x16x32_bf16 v[136:139], v[40:43], v[68:71], 0
    v_mfma_f32_16x16x32_bf16 v[132:135], v[44:47], v[64:67], 0
    v_mfma_f32_16x16x32_bf16 v[140:143], v[44:47], v[68:71], 0
    s_nop 3
    v_cvt_pk_bf16_f32 v32, v128, v129
    v_cvt_pk_bf16_f32 v33, v129, -v128
    v_cndmask_b32 v212, v32, v33, s[82:83]
    v_cvt_pk_bf16_f32 v32, v136, v137
    v_cvt_pk_bf16_f32 v33, v137, -v136
    v_cndmask_b32 v213, v32, v33, s[16:17]
    v_cvt_pk_bf16_f32 v32, v130, v131
    v_cvt_pk_bf16_f32 v33, v131, -v130
    v_cndmask_b32 v214, v32, v33, s[82:83]
    v_cvt_pk_bf16_f32 v32, v138, v139
    v_cvt_pk_bf16_f32 v33, v139, -v138
    v_cndmask_b32 v215, v32, v33, s[16:17]
    v_cvt_pk_bf16_f32 v32, v132, v133
    v_cvt_pk_bf16_f32 v33, v133, -v132
    v_cndmask_b32 v216, v32, v33, s[82:83]
    v_cvt_pk_bf16_f32 v32, v140, v141
    v_cvt_pk_bf16_f32 v33, v141, -v140
    v_cndmask_b32 v217, v32, v33, s[16:17]
    v_cvt_pk_bf16_f32 v32, v134, v135
    v_cvt_pk_bf16_f32 v33, v135, -v134
    v_cndmask_b32 v218, v32, v33, s[82:83]
    v_cvt_pk_bf16_f32 v32, v142, v143
    v_cvt_pk_bf16_f32 v33, v143, -v142
    v_cndmask_b32 v219, v32, v33, s[16:17]
    s_add_u32 s39, s78, 3936256
    buffer_store_dwordx2 v[212:213], v55, s[24:27], s39 offen sc1
    s_add_u32 s39, s78, 4050944
    buffer_store_dwordx2 v[214:215], v55, s[24:27], s39 offen sc1
    s_add_u32 s39, s78, 4853760
    buffer_store_dwordx2 v[216:217], v55, s[24:27], s39 offen sc1
    s_add_u32 s39, s78, 4968448
    buffer_store_dwordx2 v[218:219], v55, s[24:27], s39 offen sc1
L_A_stage0:
L_A_stage:
    s_mov_b32 s48, s24
    s_mov_b32 s49, s25
    s_mov_b32 s42, 0x100000
spin_30:
    ds_read_b32 v30, v19 offset:0
    s_waitcnt lgkmcnt(0)
    v_cmp_gt_u32 vcc, 1, v30
    s_sub_u32 s42, s42, 1
    s_cbranch_vccz spinx_31
    s_cbranch_scc0 spin_30
spinx_31:
    s_mov_b32 s42, 0x20000
poll_32:
    s_mov_b32 s1, 0
    s_atomic_add s1, s[46:47], s7 glc
    s_waitcnt lgkmcnt(0)
    s_cmp_ge_u32 s1, s8
    s_cbranch_scc1 pollx_33
    s_sub_u32 s42, s42, 1
    s_cbranch_scc0 poll_32
pollx_33:
L_A_polled:
    s_add_u32 m0, s66, 0
    s_sub_u32 s38, s67, 8
    s_cselect_b32 s50, 0, s26
    s_cselect_b32 s38, 0, s38
    s_mul_i32 s38, s38, 28672
    s_add_u32 s38, s38, s64
    buffer_load_dwordx4 v18, s[48:51], s38 offen offset:0 sc1 lds
    buffer_load_dwordx4 v18, s[48:51], s38 offen offset:1024 sc1 lds
    s_add_u32 m0, s66, 2048
    s_sub_u32 s38, s67, 7
    s_cselect_b32 s50, 0, s26
    s_cselect_b32 s38, 0, s38
    s_mul_i32 s38, s38, 28672
    s_add_u32 s38, s38, s64
    buffer_load_dwordx4 v18, s[48:51], s38 offen offset:0 sc1 lds
    buffer_load_dwordx4 v18, s[48:51], s38 offen offset:1024 sc1 lds
    s_add_u32 m0, s66, 4096
    s_sub_u32 s38, s67, 6
    s_cselect_b32 s50, 0, s26
    s_cselect_b32 s38, 0, s38
    s_mul_i32 s38, s38, 28672
    s_add_u32 s38, s38, s64
    buffer_load_dwordx4 v18, s[48:51], s38 offen offset:0 sc1 lds
    buffer_load_dwordx4 v18, s[48:51], s38 offen offset:1024 sc1 lds
    s_mov_b32 s68, s18
    s_mov_b32 s69, s19
    s_mov_b32 s70, 401408
    s_mov_b32 s71, 0x20000
    v_and_b32_e64 v15, 31, v0
    v_bfe_u32 v14, v0, 1, 2
    v_lshlrev_b32 v30, 1, v31
    v_xor_b32 v14, v14, v30
    v_lshlrev_b32_e64 v14, 4, v14
    v_lshl_add_u32 v14, v15, 6, v14
    s_add_u32 s39, s72, 114688
    v_add_u32 v118, s39, v14
    v_xor_b32 v119, 16, v118
    v_add_u32 v120, s39, v18
    v_lshrrev_b32 v14, 2, v0
    v_mul_u32_u24 v116, 1792, v14
    v_xor_b32 v14, v3, v16
    v_and_b32 v14, 3, v14
    v_lshl_add_u32 v116, v14, 4, v116
    v_mul_u32_u24 v30, 896, v3
    v_lshl_add_u32 v56, v7, 4, v30
    v_add_u32 v57, 6144, v56
    s_mul_i32 s73, s37, 14336
    s_lshl_b32 s39, s44, 7
    s_add_u32 s73, s73, s39
    v_bfe_u32 v14, v0, 2, 2
    v_and_b32_e64 v30, 16, v0
    v_lshl_add_u32 v30, v14, 7, v30
    v_xor_b32 v14, s37, v3
    v_and_b32 v14, 1, v14
    v_lshl_add_u32 v30, v14, 6, v30
    v_and_b32_e64 v14, 1, v0
    v_lshl_add_u32 v30, v14, 5, v30
    v_and_b32_e64 v14, 2, v0
    v_lshl_add_u32 v30, v14, 2, v30
    v_add_u32 v113, 49152, v30
    v_lshl_add_u32 v112, v31, 9, v113
    s_lshr_b32 s39, s37, 1
    s_lshl_b32 s39, s39, 15
    s_add_u32 s39, s39, 49152
    v_add_u32_e64 v117, s39, v18
    v_mul_u32_u24 v30, 3584, v31
    v_lshl_add_u32 v114, v30, 1, v113
    v_add_u32_e64 v113, v30, v113
    v_lshl_add_u32 v30, v0, 3, s39
    v_lshl_add_u32 v115, v31, 8, v30
    s_mov_b32 exec_lo, 0x0fffffff
    s_mov_b32 exec_hi, 0x0fffffff
    s_add_u32 m0, s66, 24576
    s_sub_u32 s38, s67, 8
    s_cselect_b32 s50, 0, s26
    s_cselect_b32 s38, 0, s38
    s_mul_i32 s38, s38, 28672
    s_add_u32 s38, s38, s65
    buffer_load_dwordx4 v60, s[48:51], s38 offen offset:0 sc1 lds
    buffer_load_dwordx4 v61, s[48:51], s38 offen offset:1024 sc1 lds
    s_mov_b32 s4, 1
    s_cmp_eq_u32 s77, 0
    s_cbranch_scc1 L_A_cnt0
    s_waitcnt vmcnt(8)
    s_atomic_add s4, s[46:47], s10 offset:90112 glc
L_A_cnt0:
    s_add_u32 m0, s66, 26624
    s_sub_u32 s38, s67, 7
    s_cselect_b32 s50, 0, s26
    s_cselect_b32 s38, 0, s38
    s_mul_i32 s38, s38, 28672
    s_add_u32 s38, s38, s65
    buffer_load_dwordx4 v60, s[48:51], s38 offen offset:0 sc1 lds
    buffer_load_dwordx4 v61, s[48:51], s38 offen offset:1024 sc1 lds
    s_add_u32 m0, s66, 28672
    s_sub_u32 s38, s67, 6
    s_cselect_b32 s50, 0, s26
    s_cselect_b32 s38, 0, s38
    s_mul_i32 s38, s38, 28672
    s_add_u32 s38, s38, s65
    buffer_load_dwordx4 v60, s[48:51], s38 offen offset:0 sc1 lds
    buffer_load_dwordx4 v61, s[48:51], s38 offen offset:1024 sc1 lds
    s_mov_b64 exec, -1
    s_waitcnt vmcnt(6)
    ds_write_b32 v21, v62
    s_waitcnt lgkmcnt(0)
    s_cmp_eq_u32 s4, 31
    s_cbranch_scc0 L_A_nocount
    s_atomic_add s0, s[46:47], s10 offset:94208
L_A_nocount:
    s_waitcnt vmcnt(0)
    ds_write_b32 v21, v50
    s_cmp_eq_u32 s43, 0
    s_cbranch_scc1 L_A_done
    s_and_b32 s45, s33, 0
    s_lshl_b32 s45, s45, 1
    s_add_u32 s72, s72, 49152
    s_mov_b32 s42, 0x100000
spin_34:
    ds_read_b32 v30, v19 offset:16
    s_waitcnt lgkmcnt(0)
    v_cmp_gt_u32_e64 vcc, 2, v30
    s_sub_u32 s42, s42, 1
    s_cbranch_vccz spinx_35
    s_cbranch_scc0 spin_34
spinx_35:
    s_setprio 0
    s_lshl_b32 s39, s45, 13
    s_add_u32 m0, s39, s72
    s_mul_i32 s39, s45, 57344
    s_add_u32 s39, s39, s73
    buffer_load_dwordx4 v56, s[68:71], s39 offen offset:0 lds
    buffer_load_dwordx4 v57, s[68:71], s39 offen offset:1024 lds
    s_add_u32 s45, s45, 1
    s_cmp_lg_u32 s45, 7
    s_cselect_b32 s45, s45, 0
    s_lshl_b32 s39, s45, 13
    s_add_u32 m0, s39, s72
    s_mul_i32 s39, s45, 57344
    s_add_u32 s39, s39, s73
    buffer_load_dwordx4 v56, s[68:71], s39 offen offset:0 lds
    buffer_load_dwordx4 v57, s[68:71], s39 offen offset:1024 lds
    s_add_u32 s45, s45, 1
    s_cmp_lg_u32 s45, 7
    s_cselect_b32 s45, s45, 0
    s_lshl_b32 s39, s45, 13
    s_add_u32 m0, s39, s72
    s_mul_i32 s39, s45, 57344
    s_add_u32 s39, s39, s73
    buffer_load_dwordx4 v56, s[68:71], s39 offen offset:0 lds
    buffer_load_dwordx4 v57, s[68:71], s39 offen offset:1024 lds
    s_add_u32 s45, s45, 1
    s_cmp_lg_u32 s45, 7
    s_cselect_b32 s45, s45, 0
    s_lshl_b32 s39, s45, 13
    s_add_u32 m0, s39, s72
    s_mul_i32 s39, s45, 57344
    s_add_u32 s39, s39, s73
    buffer_load_dwordx4 v56, s[68:71], s39 offen offset:0 lds
    buffer_load_dwordx4 v57, s[68:71], s39 offen offset:1024 lds
    s_add_u32 s45, s45, 1
    s_cmp_lg_u32 s45, 7
    s_cselect_b32 s45, s45, 0
    s_lshl_b32 s39, s45, 13
    s_add_u32 m0, s39, s72
    s_mul_i32 s39, s45, 57344
    s_add_u32 s39, s39, s73
    buffer_load_dwordx4 v56, s[68:71], s39 offen offset:0 lds
    buffer_load_dwordx4 v57, s[68:71], s39 offen offset:1024 lds
    s_add_u32 s45, s45, 1
    s_cmp_lg_u32 s45, 7
    s_cselect_b32 s45, s45, 0
    s_lshl_b32 s39, s45, 13
    s_add_u32 m0, s39, s72
    s_mul_i32 s39, s45, 57344
    s_add_u32 s39, s39, s73
    buffer_load_dwordx4 v56, s[68:71], s39 offen offset:0 lds
    buffer_load_dwordx4 v57, s[68:71], s39 offen offset:1024 lds
    s_add_u32 s45, s45, 1
    s_cmp_lg_u32 s45, 7
    s_cselect_b32 s45, s45, 0
    s_lshl_b32 s39, s45, 13
    s_add_u32 m0, s39, s72
    s_mul_i32 s39, s45, 57344
    s_add_u32 s39, s39, s73
    buffer_load_dwordx4 v56, s[68:71], s39 offen offset:0 lds
    buffer_load_dwordx4 v57, s[68:71], s39 offen offset:1024 lds
    s_add_u32 s45, s45, 1
    s_cmp_lg_u32 s45, 7
    s_cselect_b32 s45, s45, 0
    v_mov_b32 v30, 4
    v_mov_b32 v31, 8
    s_waitcnt vmcnt(0)
    ds_write_b32 v21, v30
    s_mov_b32 s42, 0x100000
spin_36:
    ds_read_b32 v30, v19 offset:16
    s_waitcnt lgkmcnt(0)
    v_cmp_gt_u32 vcc, 4, v30
    s_sub_u32 s42, s42, 1
    s_cbranch_vccz spinx_37
    s_sleep 1
    s_cbranch_scc0 spin_36
spinx_37:
    ds_read_b64_tr_b16 v[128:129], v112 offset:0
    ds_read_b64_tr_b16 v[130:131], v112 offset:1024
    ds_read_b64_tr_b16 v[132:133], v112 offset:3584
    ds_read_b64_tr_b16 v[134:135], v112 offset:4608
    ds_read_b64_tr_b16 v[136:137], v112 offset:7168
    ds_read_b64_tr_b16 v[138:139], v112 offset:8192
    ds_read_b64_tr_b16 v[140:141], v112 offset:10752
    ds_read_b64_tr_b16 v[142:143], v112 offset:11776
    ds_read_b64_tr_b16 v[144:145], v113 offset:2048
    ds_read_b64_tr_b16 v[146:147], v113 offset:3072
    ds_read_b64_tr_b16 v[148:149], v113 offset:9216
    ds_read_b64_tr_b16 v[150:151], v113 offset:10240
    s_waitcnt lgkmcnt(10)
    ds_read_b64_tr_b16 v[152:153], v114 offset:2560
    ds_read_b64_tr_b16 v[154:155], v114 offset:6144
    s_waitcnt lgkmcnt(10)
    ds_read_b64_tr_b16 v[160:161], v112 offset:14336
    ds_read_b64_tr_b16 v[162:163], v112 offset:15360
    s_waitcnt lgkmcnt(10)
    ds_read_b64_tr_b16 v[164:165], v112 offset:17920
    ds_read_b64_tr_b16 v[166:167], v112 offset:18944
    s_waitcnt lgkmcnt(10)
    ds_read_b64_tr_b16 v[168:169], v112 offset:21504
    ds_read_b64_tr_b16 v[170:171], v112 offset:22528
    s_waitcnt lgkmcnt(10)
    ds_read_b64_tr_b16 v[172:173], v112 offset:25088
    ds_read_b64_tr_b16 v[174:175], v112 offset:26112
    s_waitcnt lgkmcnt(10)
    ds_read_b64_tr_b16 v[176:177], v113 offset:16384
    ds_read_b64_tr_b16 v[178:179], v113 offset:17408
    s_waitcnt lgkmcnt(10)
    ds_read_b64_tr_b16 v[180:181], v113 offset:23552
    ds_read_b64_tr_b16 v[182:183], v113 offset:24576
    s_waitcnt lgkmcnt(10)
    ds_read_b64_tr_b16 v[184:185], v114 offset:16896
    ds_read_b64_tr_b16 v[186:187], v114 offset:20480
    s_waitcnt lgkmcnt(10)
    ds_read_b64_tr_b16 v[192:193], v112 offset:28672
    ds_read_b64_tr_b16 v[194:195], v112 offset:29696
    s_waitcnt lgkmcnt(10)
    ds_read_b64_tr_b16 v[196:197], v112 offset:32256
    ds_read_b64_tr_b16 v[198:199], v112 offset:33280
    s_waitcnt lgkmcnt(10)
    ds_read_b64_tr_b16 v[200:201], v112 offset:35840
    ds_read_b64_tr_b16 v[202:203], v112 offset:36864
    s_waitcnt lgkmcnt(10)
    ds_read_b64_tr_b16 v[204:205], v112 offset:39424
    ds_read_b64_tr_b16 v[206:207], v112 offset:40448
    s_waitcnt lgkmcnt(10)
    ds_read_b64_tr_b16 v[208:209], v113 offset:30720
    ds_read_b64_tr_b16 v[210:211], v113 offset:31744
    s_waitcnt lgkmcnt(10)
    ds_read_b64_tr_b16 v[212:213], v113 offset:37888
    ds_read_b64_tr_b16 v[214:215], v113 offset:38912
    s_waitcnt lgkmcnt(10)
    ds_read_b64_tr_b16 v[216:217], v114 offset:31232
    ds_read_b64_tr_b16 v[218:219], v114 offset:34816
    s_waitcnt lgkmcnt(10)
    ds_read_b64_tr_b16 v[224:225], v112 offset:43008
    ds_read_b64_tr_b16 v[226:227], v112 offset:44032
    s_waitcnt lgkmcnt(10)
    ds_read_b64_tr_b16 v[228:229], v112 offset:46592
    ds_read_b64_tr_b16 v[230:231], v112 offset:47616
    s_waitcnt lgkmcnt(10)
    ds_read_b64_tr_b16 v[232:233], v112 offset:50176
    ds_read_b64_tr_b16 v[234:235], v112 offset:51200
    s_waitcnt lgkmcnt(10)
    ds_read_b64_tr_b16 v[236:237], v112 offset:53760
    ds_read_b64_tr_b16 v[238:239], v112 offset:54784
    s_waitcnt lgkmcnt(10)
    ds_read_b64_tr_b16 v[240:241], v113 offset:45056
    ds_read_b64_tr_b16 v[242:243], v113 offset:46080
    s_waitcnt lgkmcnt(10)
    ds_read_b64_tr_b16 v[244:245], v113 offset:52224
    ds_read_b64_tr_b16 v[246:247], v113 offset:53248
    s_waitcnt lgkmcnt(10)
    ds_read_b64_tr_b16 v[248:249], v114 offset:45568
    ds_read_b64_tr_b16 v[250:251], v114 offset:49152
    s_lshl3_add_u32 s38, s75, s37
    s_lshl_b32 s41, s38, 6
    s_add_u32 s41, s41, 73728
    s_lshl_b32 s38, s38, 13
    s_add_u32 s73, s38, 5775360
    s_lshl_b32 s72, s37, 13
    s_lshr_b32 s39, s37, 1
    s_lshl1_add_u32 s78, s75, s39
    s_mul_i32 s78, s78, 57344
    s_and_b32 s40, s37, 1
    s_lshl1_add_u32 s40, s44, s40
    s_lshl_b32 s40, s40, 6
    s_add_u32 s78, s78, s40
    s_add_u32 s78, s78, 896
    v_mov_b32 v22, 10
    v_mov_b32 v23, 11
    v_mov_b32 v24, 12
    v_mov_b32 v25, 13
    s_waitcnt vmcnt(0) lgkmcnt(0)
    ds_write_b32 v21, v31
    s_setprio 2
    s_mov_b32 s42, 0x100000
spin_38:
    ds_read_b32 v30, v19 offset:16
    s_waitcnt lgkmcnt(0)
    v_cmp_gt_u32 vcc, 8, v30
    s_sub_u32 s42, s42, 1
    s_cbranch_vccz spinx_39
    s_cbranch_scc0 spin_38
spinx_39:
    s_mov_b32 s42, 0x20000
L_A_opoll:
    s_mov_b32 s1, 0
    s_mov_b32 s4, 0
    s_atomic_add s1, s[46:47], s41 glc
    s_atomic_add s4, s[46:47], s41 offset:256 glc
    s_waitcnt lgkmcnt(0)
    s_min_u32 s1, s1, s4
    s_cmp_ge_u32 s1, 4
    s_cbranch_scc1 L_A_opolled
    s_sub_u32 s42, s42, 1
    s_cbranch_scc0 L_A_opoll
L_A_opolled:
    s_add_u32 m0, s72, 49152
    s_add_u32 s74, s73, 0
    buffer_load_dwordx4 v18, s[24:27], s74 offen offset:0 sc1 lds
    buffer_load_dwordx4 v18, s[24:27], s74 offen offset:1024 sc1 lds
    s_add_u32 m0, s72, 81920
    s_add_u32 s74, s73, 32768
    buffer_load_dwordx4 v18, s[24:27], s74 offen offset:0 sc1 lds
    buffer_load_dwordx4 v18, s[24:27], s74 offen offset:1024 sc1 lds
    s_add_u32 m0, s72, 51200
    s_add_u32 s74, s73, 2048
    buffer_load_dwordx4 v18, s[24:27], s74 offen offset:0 sc1 lds
    buffer_load_dwordx4 v18, s[24:27], s74 offen offset:1024 sc1 lds
    s_add_u32 m0, s72, 83968
    s_add_u32 s74, s73, 34816
    buffer_load_dwordx4 v18, s[24:27], s74 offen offset:0 sc1 lds
    buffer_load_dwordx4 v18, s[24:27], s74 offen offset:1024 sc1 lds
    s_waitcnt vmcnt(4)
    ds_write_b32 v21, v22
    s_add_u32 m0, s72, 53248
    s_add_u32 s74, s73, 4096
    buffer_load_dwordx4 v18, s[24:27], s74 offen offset:0 sc1 lds
    buffer_load_dwordx4 v18, s[24:27], s74 offen offset:1024 sc1 lds
    s_add_u32 m0, s72, 86016
    s_add_u32 s74, s73, 36864
    buffer_load_dwordx4 v18, s[24:27], s74 offen offset:0 sc1 lds
    buffer_load_dwordx4 v18, s[24:27], s74 offen offset:1024 sc1 lds
    s_mov_b32 s42, 0x100000
spin_40:
    ds_read_b32 v30, v19 offset:16
    s_waitcnt lgkmcnt(0)
    v_cmp_gt_u32 vcc, 10, v30
    s_sub_u32 s42, s42, 1
    s_cbranch_vccz spinx_41
    s_cbranch_scc0 spin_40
spinx_41:
    ds_read_b128 v[48:51], v117 offset:0
    ds_read_b128 v[52:55], v117 offset:1024
    ds_read_b128 v[56:59], v117 offset:8192
    ds_read_b128 v[60:63], v117 offset:9216
    ds_read_b128 v[64:67], v117 offset:16384
    ds_read_b128 v[68:71], v117 offset:17408
    ds_read_b128 v[72:75], v117 offset:24576
    ds_read_b128 v[76:79], v117 offset:25600
    s_waitcnt vmcnt(4)
    ds_write_b32 v21, v23
    s_add_u32 m0, s72, 55296
    s_add_u32 s74, s73, 6144
    buffer_load_dwordx4 v18, s[24:27], s74 offen offset:0 sc1 lds
    s_add_u32 m0, s72, 88064
    s_add_u32 s74, s73, 38912
    buffer_load_dwordx4 v18, s[24:27], s74 offen offset:0 sc1 lds
    s_waitcnt lgkmcnt(8)
    v_mfma_f32_32x32x16_bf16 v[32:47], v[128:131], v[48:51], 0
    s_waitcnt lgkmcnt(7)
    v_mfma_f32_32x32x16_bf16 v[32:47], v[132:135], v[52:55], v[32:47]
    ds_read_b32 v30, v19 offset:16
    s_waitcnt lgkmcnt(7)
    v_mfma_f32_32x32x16_bf16 v[32:47], v[160:163], v[56:59], v[32:47]
    s_waitcnt lgkmcnt(6)
    v_mfma_f32_32x32x16_bf16 v[32:47], v[164:167], v[60:63], v[32:47]
    s_waitcnt lgkmcnt(0)
    v_cmp_gt_u32_e64 vcc, 11, v30
    s_nop 0
    s_cbranch_vccnz L_A_owait0
L_A_ook0:
    ds_read_b128 v[80:83], v117 offset:2048
    ds_read_b128 v[84:87], v117 offset:3072
    v_mfma_f32_32x32x16_bf16 v[32:47], v[192:195], v[64:67], v[32:47]
    ds_read_b128 v[88:91], v117 offset:10240
    ds_read_b128 v[92:95], v117 offset:11264
    v_mfma_f32_32x32x16_bf16 v[32:47], v[196:199], v[68:71], v[32:47]
    ds_read_b128 v[96:99], v117 offset:18432
    ds_read_b128 v[100:103], v117 offset:19456
    v_mfma_f32_32x32x16_bf16 v[32:47], v[224:227], v[72:75], v[32:47]
    ds_read_b128 v[104:107], v117 offset:26624
    ds_read_b128 v[108:111], v117 offset:27648
    v_mfma_f32_32x32x16_bf16 v[32:47], v[228:231], v[76:79], v[32:47]
    s_waitcnt vmcnt(2)
    ds_write_b32 v21, v24
    s_waitcnt lgkmcnt(8)
    v_mfma_f32_32x32x16_bf16 v[32:47], v[136:139], v[80:83], v[32:47]
    s_waitcnt lgkmcnt(7)
    v_mfma_f32_32x32x16_bf16 v[32:47], v[140:143], v[84:87], v[32:47]
    ds_read_b32 v30, v19 offset:16
    s_waitcnt lgkmcnt(7)
    v_mfma_f32_32x32x16_bf16 v[32:47], v[168:171], v[88:91], v[32:47]
    s_waitcnt lgkmcnt(6)
    v_mfma_f32_32x32x16_bf16 v[32:47], v[172:175], v[92:95], v[32:47]
    s_waitcnt lgkmcnt(0)
    v_cmp_gt_u32_e64 vcc, 12, v30
    s_nop 0
    s_cbranch_vccnz L_A_owait1
L_A_ook1:
    ds_read_b128 v[48:51], v117 offset:4096
    ds_read_b128 v[52:55], v117 offset:5120
    v_mfma_f32_32x32x16_bf16 v[32:47], v[200:203], v[96:99], v[32:47]
    ds_read_b128 v[56:59], v117 offset:12288
    ds_read_b128 v[60:63], v117 offset:13312
    v_mfma_f32_32x32x16_bf16 v[32:47], v[204:207], v[100:103], v[32:47]
    ds_read_b128 v[64:67], v117 offset:20480
    ds_read_b128 v[68:71], v117 offset:21504
    v_mfma_f32_32x32x16_bf16 v[32:47], v[232:235], v[104:107], v[32:47]
    ds_read_b128 v[72:75], v117 offset:28672
    ds_read_b128 v[76:79], v117 offset:29696
    v_mfma_f32_32x32x16_bf16 v[32:47], v[236:239], v[108:111], v[32:47]
    s_waitcnt vmcnt(0)
    ds_write_b32 v21, v25
    s_waitcnt lgkmcnt(8)
    v_mfma_f32_32x32x16_bf16 v[32:47], v[144:147], v[48:51], v[32:47]
    s_waitcnt lgkmcnt(7)
    v_mfma_f32_32x32x16_bf16 v[32:47], v[148:151], v[52:55], v[32:47]
    ds_read_b32 v30, v19 offset:16
    s_waitcnt lgkmcnt(7)
    v_mfma_f32_32x32x16_bf16 v[32:47], v[176:179], v[56:59], v[32:47]
    s_waitcnt lgkmcnt(6)
    v_mfma_f32_32x32x16_bf16 v[32:47], v[180:183], v[60:63], v[32:47]
    s_waitcnt lgkmcnt(0)
    v_cmp_gt_u32 vcc, 13, v30
    s_nop 0
    s_cbranch_vccnz L_A_owait2
L_A_ook2:
    ds_read_b64 v[80:81], v115 offset:6144
    ds_read_b64 v[82:83], v115 offset:6400
    v_mfma_f32_32x32x16_bf16 v[32:47], v[208:211], v[64:67], v[32:47]
    ds_read_b64 v[88:89], v115 offset:14336
    ds_read_b64 v[90:91], v115 offset:14592
    v_mfma_f32_32x32x16_bf16 v[32:47], v[212:215], v[68:71], v[32:47]
    ds_read_b64 v[96:97], v115 offset:22528
    ds_read_b64 v[98:99], v115 offset:22784
    v_mfma_f32_32x32x16_bf16 v[32:47], v[240:243], v[72:75], v[32:47]
    ds_read_b64 v[104:105], v115 offset:30720
    ds_read_b64 v[106:107], v115 offset:30976
    v_mfma_f32_32x32x16_bf16 v[32:47], v[244:247], v[76:79], v[32:47]
    s_waitcnt lgkmcnt(6)
    v_mfma_f32_32x32x16_bf16 v[32:47], v[152:155], v[80:83], v[32:47]
    s_waitcnt lgkmcnt(4)
    v_mfma_f32_32x32x16_bf16 v[32:47], v[184:187], v[88:91], v[32:47]
    s_waitcnt lgkmcnt(2)
    v_mfma_f32_32x32x16_bf16 v[32:47], v[216:219], v[96:99], v[32:47]
    s_waitcnt lgkmcnt(0)
    v_mfma_f32_32x32x16_bf16 v[32:47], v[248:251], v[104:107], v[32:47]
    s_nop 11
    v_cvt_pk_bf16_f32 v48, v32, v33
    v_cvt_pk_bf16_f32 v49, v34, v35
    v_cvt_pk_bf16_f32 v50, v36, v37
    v_cvt_pk_bf16_f32 v51, v38, v39
    ds_write_b128 v118, v[48:51]
    v_cvt_pk_bf16_f32 v52, v40, v41
    v_cvt_pk_bf16_f32 v53, v42, v43
    v_cvt_pk_bf16_f32 v54, v44, v45
    v_cvt_pk_bf16_f32 v55, v46, v47
    ds_write_b128 v119, v[52:55]
    ds_read_b128 v[56:59], v120 offset:0
    ds_read_b128 v[60:63], v120 offset:1024
    s_add_u32 s39, s78, 28672
    s_waitcnt lgkmcnt(1)
    buffer_store_dwordx4 v[56:59], v116, s[28:31], s78 offen sc1 nt
    s_waitcnt lgkmcnt(0)
    buffer_store_dwordx4 v[60:63], v116, s[28:31], s39 offen sc1 nt
L_A_done:
    s_endpgm
L_A_S:
    s_cmp_eq_u32 s15, 0
    s_cbranch_scc1 L_A_F
    s_add_u32 m0, s12, 131072
    s_bfe_u32 s45, s1, 0x30000
    s_mul_i32 s45, s45, 172032
    s_add_u32 s45, s45, s74
    buffer_load_dwordx4 v51, s[56:59], s45 offen lds
    s_add_u32 m0, s12, 135168
    s_bfe_u32 s45, s1, 0x30004
    s_mul_i32 s45, s45, 172032
    s_add_u32 s45, s45, s74
    buffer_load_dwordx4 v51, s[56:59], s45 offen lds
    s_waitcnt vmcnt(2)
    s_branch L_A_S2
L_A_F:
    s_waitcnt vmcnt(0)
L_A_S2:
    s_barrier
L_A_noa1:
    s_waitcnt vmcnt(0)
    ds_write_b32 v21, v62 offset:16
    s_setprio 2
    s_branch L_A_stage0
L_A_owait0:
    s_mov_b32 s42, 0x100000
spin_42:
    ds_read_b32 v30, v19 offset:16
    s_waitcnt lgkmcnt(0)
    v_cmp_gt_u32 vcc, 11, v30
    s_sub_u32 s42, s42, 1
    s_cbranch_vccz spinx_43
    s_cbranch_scc0 spin_42
spinx_43:
    s_branch L_A_ook0
L_A_owait1:
    s_mov_b32 s42, 0x100000
spin_44:
    ds_read_b32 v30, v19 offset:16
    s_waitcnt lgkmcnt(0)
    v_cmp_gt_u32 vcc, 12, v30
    s_sub_u32 s42, s42, 1
    s_cbranch_vccz spinx_45
    s_cbranch_scc0 spin_44
spinx_45:
    s_branch L_A_ook1
L_A_owait2:
    s_mov_b32 s42, 0x100000
spin_46:
    ds_read_b32 v30, v19 offset:16
    s_waitcnt lgkmcnt(0)
    v_cmp_gt_u32 vcc, 13, v30
    s_sub_u32 s42, s42, 1
    s_cbranch_vccz spinx_47
    s_cbranch_scc0 spin_46
spinx_47:
    s_branch L_A_ook2
    s_nop 0
L_A_P:
    s_lshl2_add_u32 s75, s32, s38
    s_mov_b32 s60, s4
    s_mov_b32 s61, s5
    s_mov_b32 s62, 1835008
    s_mov_b32 s63, 0x20000
    v_mul_u32_u24 v22, 57344, v3
    v_add_u32_e64 v22, v22, v6
    s_and_b32 s39, s37, 1
    s_lshl_b32 s39, s39, 10
    s_lshr_b32 s40, s37, 1
    s_add_u32 s39, s39, s40
    v_xor_b32 v23, 64, v22
    v_add_u32 v23, 457728, v23
    s_add_u32 s13, s72, 73728
    s_lshl1_add_u32 s39, s75, s39
    s_mul_i32 s80, s39, 896
    s_add_u32 m0, s13, 0
    s_add_u32 s45, s80, 0
    buffer_load_dwordx4 v22, s[60:63], s45 offen lds
    buffer_load_dwordx4 v23, s[60:63], s45 offen offset:1024 lds
    s_add_u32 m0, s13, 8192
    s_add_u32 s45, s80, 128
    buffer_load_dwordx4 v22, s[60:63], s45 offen lds
    buffer_load_dwordx4 v23, s[60:63], s45 offen offset:1024 lds
    s_add_u32 m0, s13, 16384
    s_add_u32 s45, s80, 256
    buffer_load_dwordx4 v22, s[60:63], s45 offen lds
    buffer_load_dwordx4 v23, s[60:63], s45 offen offset:1024 lds
    s_add_u32 m0, s13, 24576
    s_add_u32 s45, s80, 384
    buffer_load_dwordx4 v22, s[60:63], s45 offen lds
    buffer_load_dwordx4 v23, s[60:63], s45 offen offset:1024 lds
    v_lshlrev_b32_e64 v15, 2, v0
    v_add_u32 v15, 159744, v15
    v_mov_b32_e64 v28, 0
    ds_write_b32 v15, v28
    s_mov_b32 s0, 1
    s_add_u32 s46, s24, 1835008
    s_addc_u32 s47, s25, 0
    s_mov_b32 s28, s20
    s_mov_b32 s29, s21
    s_mov_b32 s30, 3670016
    s_mov_b32 s31, 0x20000
    s_lshl2_add_u32 s75, s32, s38
    s_add_u32 s76, s36, 1
    s_bfe_u32 s11, s76, 0x10001
    s_and_b32 s76, s76, 4
    s_add_u32 s81, s76, s37
    s_bitcmp1_b32 0x2a54, s35
    s_cselect_b32 s15, 1, 0
    s_bitcmp1_b32 0xaad4, s35
    s_cselect_b32 s77, 0, 1
    v_and_b32 v2, 15, v0
    v_and_b32 v16, 3, v0
    v_lshlrev_b32_e64 v19, 2, v16
    v_add_u32 v19, 159760, v19
    s_lshl2_add_u32 s38, s37, 159776
    v_mov_b32 v21, s38
    v_lshrrev_b32 v15, 2, v0
    v_mul_u32_u24 v51, 2688, v15
    v_lshl_add_u32 v51, v16, 4, v51
    s_mul_i32 s39, s35, 7
    s_lshr_b32 s39, s39, 1
    s_lshl4_add_u32 s74, s39, s74
    s_lshl_b32 s12, s37, 10
    v_mov_b32 v48, 1
    v_mov_b32 v50, 3
    v_bfe_u32 v15, v0, 1, 3
    v_xor_b32 v15, v15, v4
    v_lshlrev_b32 v15, 4, v15
    v_lshl_add_u32 v15, v2, 7, v15
    v_add_u32 v24, 73728, v15
    v_xor_b32 v25, 64, v24
    v_and_b32 v14, 1, v0
    v_cvt_f32_u32_e64 v14, v14
    v_mul_f32 v14, 0xbe800000, v14
    v_cmp_eq_u32 vcc, 1, v2
    v_lshrrev_b32 v15, 1, v2
    v_cvt_f32_u32 v28, v15
    v_and_b32 v15, 1, v15
    v_mul_u32_u24 v15, 0x8000, v15
    v_lshl_add_u32 v15, v15, 16, v15
    v_mul_f32 v28, 0x3d000000, v28
    v_cvt_f32_u32 v17, v4
    v_mul_f32 v17, 4.0, v17
    v_add_f32 v29, 0x3e800000, v28
    v_fma_f32 v30, v17, v29, v14
    v_add_f32_e64 v33, v29, v30
    v_fma_f32 v34, v29, 2.0, v30
    v_fma_f32 v35, v29, 2.0, v33
    v_cos_f32 v32, v30
    v_cos_f32 v33, v33
    v_cos_f32 v34, v34
    v_cos_f32 v35, v35
    v_cvt_pk_bf16_f32 v44, v32, v33
    v_cvt_pk_bf16_f32 v45, v34, v35
    v_xor_b32 v46, v15, v44
    v_xor_b32 v47, v15, v45
    v_cndmask_b32 v29, v28, 0.5, vcc
    v_cndmask_b32 v14, v14, 0, vcc
    v_fma_f32 v30, v17, v29, v14
    v_add_f32_e64 v33, v29, v30
    v_fma_f32 v34, v29, 2.0, v30
    v_fma_f32 v35, v29, 2.0, v33
    v_cos_f32 v32, v30
    v_cos_f32 v33, v33
    v_cos_f32 v34, v34
    v_cos_f32 v35, v35
    v_cvt_pk_bf16_f32 v40, v32, v33
    v_cvt_pk_bf16_f32 v41, v34, v35
    v_xor_b32_e64 v42, v15, v40
    v_xor_b32 v43, v15, v41
    s_mul_i32 s66, s37, 3
    s_lshl2_add_u32 s67, s34, s66
    s_lshl_b32 s66, s66, 11
    s_mul_i32 s38, s35, 7
    s_lshr_b32 s64, s38, 1
    s_lshl_b32 s64, s64, 9
    s_lshl_b32 s65, s38, 6
    s_add_u32 s65, s65, 2097152
    s_lshl4_add_u32 s7, s34, s35
    s_lshl2_add_u32 s7, s7, s37
    s_lshl_b32 s7, s7, 6
    s_max_u32 s8, s67, 5
    s_sub_u32 s8, s8, 5
    s_min_u32 s8, s8, 3
    s_add_u32 s38, s15, 1
    s_lshl_b32 s8, s8, s38
    v_lshlrev_b32 v18, 4, v0
    v_lshrrev_b32 v31, 5, v0
    v_mul_u32_u24 v60, 6656, v31
    v_add_u32_e64 v60, v60, v18
    v_add_u32 v61, 13312, v60
    v_mov_b32_e64 v62, 2
    v_mul_u32_u24 v55, 229376, v4
    s_mul_i32 s78, s75, 3584
    v_mad_u32_u24 v55, v2, 12, v55
    s_mul_i32 s39, s37, 192
    s_add_u32 s78, s78, s39
    s_add_u32 s78, s78, 1024
    s_add_u32 s10, s37, 16
    v_lshlrev_b32 v26, 31, v0
    v_lshrrev_b32 v15, 16, v26
    v_or_b32_e64 v26, v15, v26
    v_xor_b32 v27, 0x80008000, v26
    s_lshl_b32 s10, s10, 7
    s_mul_i32 s39, s37, 48
    s_add_u32 s39, s39, 256
    v_mad_u32_u24 v14, v2, 3, s39
    v_cmp_lt_u32 vcc, 224, v14
    v_cvt_f32_u32_e64 v14, v14
    v_cvt_f32_u32 v17, v4
    s_mov_b64 s[82:83], vcc
    v_mul_f32 v28, 0x3b124925, v14
    v_mul_f32 v30, 0x3d924925, v14
    v_mov_b32 v29, 0x3e800000
    v_cndmask_b32 v29, 0, v29, vcc
    v_cos_f32 v30, v30
    v_mul_f32 v14, 0x41000000, v17
    v_fma_f32 v29, v14, v28, v29
    v_add_f32_e64 v30, v30, v30
    v_fmamk_f32 v196, v28, 0x00000000, v29
    v_fmamk_f32 v197, v28, 0x3f800000, v29
    v_fmamk_f32 v198, v28, 0x40000000, v29
    v_fmamk_f32 v199, v28, 0x40400000, v29
    v_fmamk_f32 v200, v28, 0x40800000, v29
    v_fmamk_f32 v201, v28, 0x40a00000, v29
    v_fmamk_f32 v202, v28, 0x40c00000, v29
    v_fmamk_f32 v203, v28, 0x40e00000, v29
    v_cos_f32 v196, v196
    v_cos_f32 v197, v197
    v_cos_f32 v198, v198
    v_cos_f32 v199, v199
    v_cos_f32 v200, v200
    v_cos_f32 v201, v201
    v_cos_f32 v202, v202
    v_cos_f32 v203, v203
    v_fmamk_f32 v204, v28, 0x42000000, v29
    v_fmamk_f32 v205, v28, 0x42040000, v29
    v_fmamk_f32 v206, v28, 0x42080000, v29
    v_fmamk_f32 v207, v28, 0x420c0000, v29
    v_fmamk_f32 v208, v28, 0x42100000, v29
    v_fmamk_f32 v209, v28, 0x42140000, v29
    v_fmamk_f32 v210, v28, 0x42180000, v29
    v_fmamk_f32 v211, v28, 0x421c0000, v29
    v_cos_f32 v204, v204
    v_cos_f32 v205, v205
    v_cos_f32 v206, v206
    v_cos_f32 v207, v207
    v_cos_f32 v208, v208
    v_cos_f32 v209, v209
    v_cos_f32 v210, v210
    v_cos_f32 v211, v211
    v_cvt_pk_bf16_f32 v64, v196, v197
    v_cvt_pk_bf16_f32 v65, v198, v199
    v_cvt_pk_bf16_f32 v66, v200, v201
    v_cvt_pk_bf16_f32 v67, v202, v203
    v_pk_fma_f32 v[196:197], v[204:205], v[30:31], v[196:197] op_sel_hi:[1,0,1] neg_lo:[0,0,1] neg_hi:[0,0,1]
    v_pk_fma_f32 v[198:199], v[206:207], v[30:31], v[198:199] op_sel_hi:[1,0,1] neg_lo:[0,0,1] neg_hi:[0,0,1]
    v_pk_fma_f32 v[200:201], v[208:209], v[30:31], v[200:201] op_sel_hi:[1,0,1] neg_lo:[0,0,1] neg_hi:[0,0,1]
    v_pk_fma_f32 v[202:203], v[210:211], v[30:31], v[202:203] op_sel_hi:[1,0,1] neg_lo:[0,0,1] neg_hi:[0,0,1]
    v_cvt_pk_bf16_f32 v68, v204, v205
    v_cvt_pk_bf16_f32 v69, v206, v207
    v_cvt_pk_bf16_f32 v70, v208, v209
    v_cvt_pk_bf16_f32 v71, v210, v211
    v_pk_fma_f32 v[204:205], v[196:197], v[30:31], v[204:205] op_sel_hi:[1,0,1] neg_lo:[0,0,1] neg_hi:[0,0,1]
    v_pk_fma_f32 v[206:207], v[198:199], v[30:31], v[206:207] op_sel_hi:[1,0,1] neg_lo:[0,0,1] neg_hi:[0,0,1]
    v_pk_fma_f32 v[208:209], v[200:201], v[30:31], v[208:209] op_sel_hi:[1,0,1] neg_lo:[0,0,1] neg_hi:[0,0,1]
    v_pk_fma_f32 v[210:211], v[202:203], v[30:31], v[210:211] op_sel_hi:[1,0,1] neg_lo:[0,0,1] neg_hi:[0,0,1]
    v_cvt_pk_bf16_f32 v72, v196, v197
    v_cvt_pk_bf16_f32 v73, v198, v199
    v_cvt_pk_bf16_f32 v74, v200, v201
    v_cvt_pk_bf16_f32 v75, v202, v203
    v_pk_fma_f32 v[196:197], v[204:205], v[30:31], v[196:197] op_sel_hi:[1,0,1] neg_lo:[0,0,1] neg_hi:[0,0,1]
    v_pk_fma_f32 v[198:199], v[206:207], v[30:31], v[198:199] op_sel_hi:[1,0,1] neg_lo:[0,0,1] neg_hi:[0,0,1]
    v_pk_fma_f32 v[200:201], v[208:209], v[30:31], v[200:201] op_sel_hi:[1,0,1] neg_lo:[0,0,1] neg_hi:[0,0,1]
    v_pk_fma_f32 v[202:203], v[210:211], v[30:31], v[202:203] op_sel_hi:[1,0,1] neg_lo:[0,0,1] neg_hi:[0,0,1]
    v_cvt_pk_bf16_f32 v76, v204, v205
    v_cvt_pk_bf16_f32 v77, v206, v207
    v_cvt_pk_bf16_f32 v78, v208, v209
    v_cvt_pk_bf16_f32 v79, v210, v211
    v_pk_fma_f32 v[204:205], v[196:197], v[30:31], v[204:205] op_sel_hi:[1,0,1] neg_lo:[0,0,1] neg_hi:[0,0,1]
    v_pk_fma_f32 v[206:207], v[198:199], v[30:31], v[206:207] op_sel_hi:[1,0,1] neg_lo:[0,0,1] neg_hi:[0,0,1]
    v_pk_fma_f32 v[208:209], v[200:201], v[30:31], v[208:209] op_sel_hi:[1,0,1] neg_lo:[0,0,1] neg_hi:[0,0,1]
    v_pk_fma_f32 v[210:211], v[202:203], v[30:31], v[210:211] op_sel_hi:[1,0,1] neg_lo:[0,0,1] neg_hi:[0,0,1]
    v_cvt_pk_bf16_f32 v80, v196, v197
    v_cvt_pk_bf16_f32 v81, v198, v199
    v_cvt_pk_bf16_f32 v82, v200, v201
    v_cvt_pk_bf16_f32 v83, v202, v203
    v_pk_fma_f32 v[196:197], v[204:205], v[30:31], v[196:197] op_sel_hi:[1,0,1] neg_lo:[0,0,1] neg_hi:[0,0,1]
    v_pk_fma_f32 v[198:199], v[206:207], v[30:31], v[198:199] op_sel_hi:[1,0,1] neg_lo:[0,0,1] neg_hi:[0,0,1]
    v_pk_fma_f32 v[200:201], v[208:209], v[30:31], v[200:201] op_sel_hi:[1,0,1] neg_lo:[0,0,1] neg_hi:[0,0,1]
    v_pk_fma_f32 v[202:203], v[210:211], v[30:31], v[202:203] op_sel_hi:[1,0,1] neg_lo:[0,0,1] neg_hi:[0,0,1]
    v_cvt_pk_bf16_f32 v84, v204, v205
    v_cvt_pk_bf16_f32 v85, v206, v207
    v_cvt_pk_bf16_f32 v86, v208, v209
    v_cvt_pk_bf16_f32 v87, v210, v211
    v_cvt_pk_bf16_f32 v88, v196, v197
    v_cvt_pk_bf16_f32 v89, v198, v199
    v_cvt_pk_bf16_f32 v90, v200, v201
    v_cvt_pk_bf16_f32 v91, v202, v203
    s_mul_i32 s39, s37, 48
    s_add_u32 s39, s39, 257
    v_mad_u32_u24 v14, v2, 3, s39
    v_cmp_lt_u32 vcc, 224, v14
    v_cvt_f32_u32 v14, v14
    v_cvt_f32_u32 v17, v4
    s_mov_b64 s[82:83], vcc
    v_mul_f32 v28, 0x3b124925, v14
    v_mul_f32 v30, 0x3d924925, v14
    v_mov_b32 v29, 0x3e800000
    v_cndmask_b32 v29, 0, v29, vcc
    v_cos_f32 v30, v30
    v_mul_f32 v14, 0x41000000, v17
    v_fma_f32 v29, v14, v28, v29
    v_add_f32_e64 v30, v30, v30
    v_fmamk_f32 v196, v28, 0x00000000, v29
    v_fmamk_f32 v197, v28, 0x3f800000, v29
    v_fmamk_f32 v198, v28, 0x40000000, v29
    v_fmamk_f32 v199, v28, 0x40400000, v29
    v_fmamk_f32 v200, v28, 0x40800000, v29
    v_fmamk_f32 v201, v28, 0x40a00000, v29
    v_fmamk_f32 v202, v28, 0x40c00000, v29
    v_fmamk_f32 v203, v28, 0x40e00000, v29
    v_cos_f32 v196, v196
    v_cos_f32 v197, v197
    v_cos_f32 v198, v198
    v_cos_f32 v199, v199
    v_cos_f32 v200, v200
    v_cos_f32 v201, v201
    v_cos_f32 v202, v202
    v_cos_f32 v203, v203
    v_fmamk_f32 v204, v28, 0x42000000, v29
    v_fmamk_f32 v205, v28, 0x42040000, v29
    v_fmamk_f32 v206, v28, 0x42080000, v29
    v_fmamk_f32 v207, v28, 0x420c0000, v29
    v_fmamk_f32 v208, v28, 0x42100000, v29
    v_fmamk_f32 v209, v28, 0x42140000, v29
    v_fmamk_f32 v210, v28, 0x42180000, v29
    v_fmamk_f32 v211, v28, 0x421c0000, v29
    v_cos_f32 v204, v204
    v_cos_f32 v205, v205
    v_cos_f32 v206, v206
    v_cos_f32 v207, v207
    v_cos_f32 v208, v208
    v_cos_f32 v209, v209
    v_cos_f32 v210, v210
    v_cos_f32 v211, v211
    v_cvt_pk_bf16_f32 v92, v196, v197
    v_cvt_pk_bf16_f32 v93, v198, v199
    v_cvt_pk_bf16_f32 v94, v200, v201
    v_cvt_pk_bf16_f32 v95, v202, v203
    v_pk_fma_f32 v[196:197], v[204:205], v[30:31], v[196:197] op_sel_hi:[1,0,1] neg_lo:[0,0,1] neg_hi:[0,0,1]
    v_pk_fma_f32 v[198:199], v[206:207], v[30:31], v[198:199] op_sel_hi:[1,0,1] neg_lo:[0,0,1] neg_hi:[0,0,1]
    v_pk_fma_f32 v[200:201], v[208:209], v[30:31], v[200:201] op_sel_hi:[1,0,1] neg_lo:[0,0,1] neg_hi:[0,0,1]
    v_pk_fma_f32 v[202:203], v[210:211], v[30:31], v[202:203] op_sel_hi:[1,0,1] neg_lo:[0,0,1] neg_hi:[0,0,1]
    v_cvt_pk_bf16_f32 v96, v204, v205
    v_cvt_pk_bf16_f32 v97, v206, v207
    v_cvt_pk_bf16_f32 v98, v208, v209
    v_cvt_pk_bf16_f32 v99, v210, v211
    v_pk_fma_f32 v[204:205], v[196:197], v[30:31], v[204:205] op_sel_hi:[1,0,1] neg_lo:[0,0,1] neg_hi:[0,0,1]
    v_pk_fma_f32 v[206:207], v[198:199], v[30:31], v[206:207] op_sel_hi:[1,0,1] neg_lo:[0,0,1] neg_hi:[0,0,1]
    v_pk_fma_f32 v[208:209], v[200:201], v[30:31], v[208:209] op_sel_hi:[1,0,1] neg_lo:[0,0,1] neg_hi:[0,0,1]
    v_pk_fma_f32 v[210:211], v[202:203], v[30:31], v[210:211] op_sel_hi:[1,0,1] neg_lo:[0,0,1] neg_hi:[0,0,1]
    v_cvt_pk_bf16_f32 v100, v196, v197
    v_cvt_pk_bf16_f32 v101, v198, v199
    v_cvt_pk_bf16_f32 v102, v200, v201
    v_cvt_pk_bf16_f32 v103, v202, v203
    v_pk_fma_f32 v[196:197], v[204:205], v[30:31], v[196:197] op_sel_hi:[1,0,1] neg_lo:[0,0,1] neg_hi:[0,0,1]
    v_pk_fma_f32 v[198:199], v[206:207], v[30:31], v[198:199] op_sel_hi:[1,0,1] neg_lo:[0,0,1] neg_hi:[0,0,1]
    v_pk_fma_f32 v[200:201], v[208:209], v[30:31], v[200:201] op_sel_hi:[1,0,1] neg_lo:[0,0,1] neg_hi:[0,0,1]
    v_pk_fma_f32 v[202:203], v[210:211], v[30:31], v[202:203] op_sel_hi:[1,0,1] neg_lo:[0,0,1] neg_hi:[0,0,1]
    v_cvt_pk_bf16_f32 v104, v204, v205
    v_cvt_pk_bf16_f32 v105, v206, v207
    v_cvt_pk_bf16_f32 v106, v208, v209
    v_cvt_pk_bf16_f32 v107, v210, v211
    v_pk_fma_f32 v[204:205], v[196:197], v[30:31], v[204:205] op_sel_hi:[1,0,1] neg_lo:[0,0,1] neg_hi:[0,0,1]
    v_pk_fma_f32 v[206:207], v[198:199], v[30:31], v[206:207] op_sel_hi:[1,0,1] neg_lo:[0,0,1] neg_hi:[0,0,1]
    v_pk_fma_f32 v[208:209], v[200:201], v[30:31], v[208:209] op_sel_hi:[1,0,1] neg_lo:[0,0,1] neg_hi:[0,0,1]
    v_pk_fma_f32 v[210:211], v[202:203], v[30:31], v[210:211] op_sel_hi:[1,0,1] neg_lo:[0,0,1] neg_hi:[0,0,1]
    v_cvt_pk_bf16_f32 v108, v196, v197
    v_cvt_pk_bf16_f32 v109, v198, v199
    v_cvt_pk_bf16_f32 v110, v200, v201
    v_cvt_pk_bf16_f32 v111, v202, v203
    v_pk_fma_f32 v[196:197], v[204:205], v[30:31], v[196:197] op_sel_hi:[1,0,1] neg_lo:[0,0,1] neg_hi:[0,0,1]
    v_pk_fma_f32 v[198:199], v[206:207], v[30:31], v[198:199] op_sel_hi:[1,0,1] neg_lo:[0,0,1] neg_hi:[0,0,1]
    v_pk_fma_f32 v[200:201], v[208:209], v[30:31], v[200:201] op_sel_hi:[1,0,1] neg_lo:[0,0,1] neg_hi:[0,0,1]
    v_pk_fma_f32 v[202:203], v[210:211], v[30:31], v[202:203] op_sel_hi:[1,0,1] neg_lo:[0,0,1] neg_hi:[0,0,1]
    v_cvt_pk_bf16_f32 v112, v204, v205
    v_cvt_pk_bf16_f32 v113, v206, v207
    v_cvt_pk_bf16_f32 v114, v208, v209
    s_add_u32 m0, s13, 32768
    s_add_u32 s45, s80, 512
    buffer_load_dwordx4 v22, s[60:63], s45 offen lds
    buffer_load_dwordx4 v23, s[60:63], s45 offen offset:1024 lds
    s_add_u32 m0, s13, 40960
    s_add_u32 s45, s80, 640
    buffer_load_dwordx4 v22, s[60:63], s45 offen lds
    buffer_load_dwordx4 v23, s[60:63], s45 offen offset:1024 lds
    s_add_u32 m0, s13, 49152
    s_add_u32 s45, s80, 768
    buffer_load_dwordx4 v22, s[60:63], s45 offen lds
    buffer_load_dwordx4 v23, s[60:63], s45 offen offset:1024 lds
    s_waitcnt lgkmcnt(0)
    s_barrier
    v_cvt_pk_bf16_f32 v115, v210, v211
    v_cvt_pk_bf16_f32 v116, v196, v197
    v_cvt_pk_bf16_f32 v117, v198, v199
    v_cvt_pk_bf16_f32 v118, v200, v201
    v_cvt_pk_bf16_f32 v119, v202, v203
    s_mul_i32 s39, s37, 48
    s_add_u32 s39, s39, 258
    v_mad_u32_u24 v14, v2, 3, s39
    v_cmp_lt_u32 vcc, 224, v14
    v_cvt_f32_u32 v14, v14
    v_cvt_f32_u32 v17, v4
    s_mov_b64 s[82:83], vcc
    v_mul_f32 v28, 0x3b124925, v14
    v_mul_f32 v30, 0x3d924925, v14
    v_mov_b32 v29, 0x3e800000
    v_cndmask_b32 v29, 0, v29, vcc
    v_cos_f32 v30, v30
    v_mul_f32 v14, 0x41000000, v17
    v_fma_f32 v29, v14, v28, v29
    v_add_f32_e64 v30, v30, v30
    v_fmamk_f32 v196, v28, 0x00000000, v29
    v_fmamk_f32 v197, v28, 0x3f800000, v29
    v_fmamk_f32 v198, v28, 0x40000000, v29
    v_fmamk_f32 v199, v28, 0x40400000, v29
    v_fmamk_f32 v200, v28, 0x40800000, v29
    v_fmamk_f32 v201, v28, 0x40a00000, v29
    v_fmamk_f32 v202, v28, 0x40c00000, v29
    v_fmamk_f32 v203, v28, 0x40e00000, v29
    v_cos_f32 v196, v196
    v_cos_f32 v197, v197
    v_cos_f32 v198, v198
    v_cos_f32 v199, v199
    v_cos_f32 v200, v200
    v_cos_f32 v201, v201
    v_cos_f32 v202, v202
    v_cos_f32 v203, v203
    v_fmamk_f32 v204, v28, 0x42000000, v29
    v_fmamk_f32 v205, v28, 0x42040000, v29
    v_fmamk_f32 v206, v28, 0x42080000, v29
    v_fmamk_f32 v207, v28, 0x420c0000, v29
    v_fmamk_f32 v208, v28, 0x42100000, v29
    v_fmamk_f32 v209, v28, 0x42140000, v29
    v_fmamk_f32 v210, v28, 0x42180000, v29
    v_fmamk_f32 v211, v28, 0x421c0000, v29
    v_cos_f32 v204, v204
    v_cos_f32 v205, v205
    v_cos_f32 v206, v206
    v_cos_f32 v207, v207
    v_cos_f32 v208, v208
    v_cos_f32 v209, v209
    v_cos_f32 v210, v210
    v_cos_f32 v211, v211
    v_cvt_pk_bf16_f32 v120, v196, v197
    v_cvt_pk_bf16_f32 v121, v198, v199
    v_cvt_pk_bf16_f32 v122, v200, v201
    v_cvt_pk_bf16_f32 v123, v202, v203
    v_pk_fma_f32 v[196:197], v[204:205], v[30:31], v[196:197] op_sel_hi:[1,0,1] neg_lo:[0,0,1] neg_hi:[0,0,1]
    v_pk_fma_f32 v[198:199], v[206:207], v[30:31], v[198:199] op_sel_hi:[1,0,1] neg_lo:[0,0,1] neg_hi:[0,0,1]
    v_pk_fma_f32 v[200:201], v[208:209], v[30:31], v[200:201] op_sel_hi:[1,0,1] neg_lo:[0,0,1] neg_hi:[0,0,1]
    v_pk_fma_f32 v[202:203], v[210:211], v[30:31], v[202:203] op_sel_hi:[1,0,1] neg_lo:[0,0,1] neg_hi:[0,0,1]
    v_cvt_pk_bf16_f32 v124, v204, v205
    v_cvt_pk_bf16_f32 v125, v206, v207
    v_cvt_pk_bf16_f32 v126, v208, v209
    v_cvt_pk_bf16_f32 v127, v210, v211
    v_pk_fma_f32 v[204:205], v[196:197], v[30:31], v[204:205] op_sel_hi:[1,0,1] neg_lo:[0,0,1] neg_hi:[0,0,1]
    v_pk_fma_f32 v[206:207], v[198:199], v[30:31], v[206:207] op_sel_hi:[1,0,1] neg_lo:[0,0,1] neg_hi:[0,0,1]
    v_pk_fma_f32 v[208:209], v[200:201], v[30:31], v[208:209] op_sel_hi:[1,0,1] neg_lo:[0,0,1] neg_hi:[0,0,1]
    v_pk_fma_f32 v[210:211], v[202:203], v[30:31], v[210:211] op_sel_hi:[1,0,1] neg_lo:[0,0,1] neg_hi:[0,0,1]
    v_cvt_pk_bf16_f32 v128, v196, v197
    v_cvt_pk_bf16_f32 v129, v198, v199
    v_cvt_pk_bf16_f32 v130, v200, v201
    v_cvt_pk_bf16_f32 v131, v202, v203
    v_pk_fma_f32 v[196:197], v[204:205], v[30:31], v[196:197] op_sel_hi:[1,0,1] neg_lo:[0,0,1] neg_hi:[0,0,1]
    v_pk_fma_f32 v[198:199], v[206:207], v[30:31], v[198:199] op_sel_hi:[1,0,1] neg_lo:[0,0,1] neg_hi:[0,0,1]
    v_pk_fma_f32 v[200:201], v[208:209], v[30:31], v[200:201] op_sel_hi:[1,0,1] neg_lo:[0,0,1] neg_hi:[0,0,1]
    v_pk_fma_f32 v[202:203], v[210:211], v[30:31], v[202:203] op_sel_hi:[1,0,1] neg_lo:[0,0,1] neg_hi:[0,0,1]
    v_cvt_pk_bf16_f32 v132, v204, v205
    v_cvt_pk_bf16_f32 v133, v206, v207
    v_cvt_pk_bf16_f32 v134, v208, v209
    v_cvt_pk_bf16_f32 v135, v210, v211
    v_pk_fma_f32 v[204:205], v[196:197], v[30:31], v[204:205] op_sel_hi:[1,0,1] neg_lo:[0,0,1] neg_hi:[0,0,1]
    v_pk_fma_f32 v[206:207], v[198:199], v[30:31], v[206:207] op_sel_hi:[1,0,1] neg_lo:[0,0,1] neg_hi:[0,0,1]
    v_pk_fma_f32 v[208:209], v[200:201], v[30:31], v[208:209] op_sel_hi:[1,0,1] neg_lo:[0,0,1] neg_hi:[0,0,1]
    v_pk_fma_f32 v[210:211], v[202:203], v[30:31], v[210:211] op_sel_hi:[1,0,1] neg_lo:[0,0,1] neg_hi:[0,0,1]
    v_cvt_pk_bf16_f32 v136, v196, v197
    v_cvt_pk_bf16_f32 v137, v198, v199
    v_cvt_pk_bf16_f32 v138, v200, v201
    v_cvt_pk_bf16_f32 v139, v202, v203
    v_pk_fma_f32 v[196:197], v[204:205], v[30:31], v[196:197] op_sel_hi:[1,0,1] neg_lo:[0,0,1] neg_hi:[0,0,1]
    v_pk_fma_f32 v[198:199], v[206:207], v[30:31], v[198:199] op_sel_hi:[1,0,1] neg_lo:[0,0,1] neg_hi:[0,0,1]
    v_pk_fma_f32 v[200:201], v[208:209], v[30:31], v[200:201] op_sel_hi:[1,0,1] neg_lo:[0,0,1] neg_hi:[0,0,1]
    v_pk_fma_f32 v[202:203], v[210:211], v[30:31], v[202:203] op_sel_hi:[1,0,1] neg_lo:[0,0,1] neg_hi:[0,0,1]
    v_cvt_pk_bf16_f32 v140, v204, v205
    v_cvt_pk_bf16_f32 v141, v206, v207
    v_cvt_pk_bf16_f32 v142, v208, v209
    v_cvt_pk_bf16_f32 v143, v210, v211
    v_cvt_pk_bf16_f32 v144, v196, v197
    v_cvt_pk_bf16_f32 v145, v198, v199
    v_cvt_pk_bf16_f32 v146, v200, v201
    v_cvt_pk_bf16_f32 v147, v202, v203
    s_mov_b32 s77, 1
    ds_write_b32 v21, v62 offset:16
    s_waitcnt vmcnt(0)
    ds_write_b32 v21, v48
    s_mov_b32 s42, 0x100000
spin_48:
    ds_read_b32 v30, v19 offset:16
    s_waitcnt lgkmcnt(0)
    v_cmp_gt_u32 vcc, 1, v30
    s_sub_u32 s42, s42, 1
    s_cbranch_vccz spinx_49
    s_cbranch_scc0 spin_48
spinx_49:
    ds_read_b128 v[196:199], v24 offset:0
    ds_read_b128 v[200:203], v24 offset:2048
    ds_read_b128 v[204:207], v24 offset:4096
    ds_read_b128 v[208:211], v24 offset:6144
    ds_read_b128 v[212:215], v25 offset:0
    ds_read_b128 v[216:219], v25 offset:2048
    ds_read_b128 v[220:223], v25 offset:4096
    ds_read_b128 v[224:227], v25 offset:6144
    ds_read_b128 v[228:231], v24 offset:8192
    ds_read_b128 v[232:235], v24 offset:10240
    ds_read_b128 v[236:239], v24 offset:12288
    ds_read_b128 v[240:243], v24 offset:14336
    s_waitcnt lgkmcnt(8)
    v_mfma_f32_16x16x32_bf16 v[148:151], v[196:199], v[64:67], 0
    v_mfma_f32_16x16x32_bf16 v[152:155], v[200:203], v[64:67], 0
    v_mfma_f32_16x16x32_bf16 v[156:159], v[204:207], v[64:67], 0
    v_mfma_f32_16x16x32_bf16 v[160:163], v[208:211], v[64:67], 0
    v_mfma_f32_16x16x32_bf16 v[164:167], v[196:199], v[92:95], 0
    v_mfma_f32_16x16x32_bf16 v[168:171], v[200:203], v[92:95], 0
    v_mfma_f32_16x16x32_bf16 v[172:175], v[204:207], v[92:95], 0
    v_mfma_f32_16x16x32_bf16 v[176:179], v[208:211], v[92:95], 0
    v_mfma_f32_16x16x32_bf16 v[180:183], v[196:199], v[120:123], 0
    v_mfma_f32_16x16x32_bf16 v[184:187], v[200:203], v[120:123], 0
    v_mfma_f32_16x16x32_bf16 v[188:191], v[204:207], v[120:123], 0
    v_mfma_f32_16x16x32_bf16 v[192:195], v[208:211], v[120:123], 0
    ds_read_b128 v[196:199], v25 offset:8192
    ds_read_b128 v[200:203], v25 offset:10240
    ds_read_b128 v[204:207], v25 offset:12288
    ds_read_b128 v[208:211], v25 offset:14336
    s_waitcnt lgkmcnt(8)
    v_mfma_f32_16x16x32_bf16 v[148:151], v[212:215], v[68:71], v[148:151]
    v_xor_b32 v64, v26, v64
    v_mfma_f32_16x16x32_bf16 v[152:155], v[216:219], v[68:71], v[152:155]
    v_xor_b32_e64 v65, v26, v65
    v_mfma_f32_16x16x32_bf16 v[156:159], v[220:223], v[68:71], v[156:159]
    v_xor_b32_e64 v66, v26, v66
    v_mfma_f32_16x16x32_bf16 v[160:163], v[224:227], v[68:71], v[160:163]
    v_xor_b32_e64 v67, v26, v67
    v_mfma_f32_16x16x32_bf16 v[164:167], v[212:215], v[96:99], v[164:167]
    v_xor_b32_e64 v92, v27, v92
    v_mfma_f32_16x16x32_bf16 v[168:171], v[216:219], v[96:99], v[168:171]
    v_xor_b32_e64 v93, v27, v93
    v_mfma_f32_16x16x32_bf16 v[172:175], v[220:223], v[96:99], v[172:175]
    v_xor_b32_e64 v94, v27, v94
    v_mfma_f32_16x16x32_bf16 v[176:179], v[224:227], v[96:99], v[176:179]
    v_xor_b32_e64 v95, v27, v95
    v_mfma_f32_16x16x32_bf16 v[180:183], v[212:215], v[124:127], v[180:183]
    v_xor_b32_e64 v120, v26, v120
    v_mfma_f32_16x16x32_bf16 v[184:187], v[216:219], v[124:127], v[184:187]
    v_xor_b32_e64 v121, v26, v121
    v_mfma_f32_16x16x32_bf16 v[188:191], v[220:223], v[124:127], v[188:191]
    v_xor_b32_e64 v122, v26, v122
    v_mfma_f32_16x16x32_bf16 v[192:195], v[224:227], v[124:127], v[192:195]
    v_xor_b32_e64 v123, v26, v123
    ds_read_b128 v[212:215], v24 offset:16384
    ds_read_b128 v[216:219], v24 offset:18432
    ds_read_b128 v[220:223], v24 offset:20480
    ds_read_b128 v[224:227], v24 offset:22528
    s_waitcnt lgkmcnt(8)
    v_mfma_f32_16x16x32_bf16 v[148:151], v[228:231], v[72:75], v[148:151]
    v_xor_b32 v68, v26, v68
    v_mfma_f32_16x16x32_bf16 v[152:155], v[232:235], v[72:75], v[152:155]
    v_xor_b32_e64 v69, v26, v69
    v_mfma_f32_16x16x32_bf16 v[156:159], v[236:239], v[72:75], v[156:159]
    v_xor_b32_e64 v70, v26, v70
    v_mfma_f32_16x16x32_bf16 v[160:163], v[240:243], v[72:75], v[160:163]
    v_xor_b32_e64 v71, v26, v71
    v_mfma_f32_16x16x32_bf16 v[164:167], v[228:231], v[100:103], v[164:167]
    v_xor_b32_e64 v96, v27, v96
    v_mfma_f32_16x16x32_bf16 v[168:171], v[232:235], v[100:103], v[168:171]
    v_xor_b32_e64 v97, v27, v97
    v_mfma_f32_16x16x32_bf16 v[172:175], v[236:239], v[100:103], v[172:175]
    v_xor_b32_e64 v98, v27, v98
    v_mfma_f32_16x16x32_bf16 v[176:179], v[240:243], v[100:103], v[176:179]
    v_xor_b32_e64 v99, v27, v99
    v_mfma_f32_16x16x32_bf16 v[180:183], v[228:231], v[128:131], v[180:183]
    v_xor_b32_e64 v124, v26, v124
    v_mfma_f32_16x16x32_bf16 v[184:187], v[232:235], v[128:131], v[184:187]
    v_xor_b32_e64 v125, v26, v125
    v_mfma_f32_16x16x32_bf16 v[188:191], v[236:239], v[128:131], v[188:191]
    v_xor_b32_e64 v126, v26, v126
    v_mfma_f32_16x16x32_bf16 v[192:195], v[240:243], v[128:131], v[192:195]
    v_xor_b32_e64 v127, v26, v127
    ds_read_b128 v[228:231], v25 offset:16384
    ds_read_b128 v[232:235], v25 offset:18432
    ds_read_b128 v[236:239], v25 offset:20480
    ds_read_b128 v[240:243], v25 offset:22528
    s_waitcnt lgkmcnt(8)
    v_mfma_f32_16x16x32_bf16 v[148:151], v[196:199], v[76:79], v[148:151]
    v_xor_b32 v72, v26, v72
    v_mfma_f32_16x16x32_bf16 v[152:155], v[200:203], v[76:79], v[152:155]
    v_xor_b32_e64 v73, v26, v73
    v_mfma_f32_16x16x32_bf16 v[156:159], v[204:207], v[76:79], v[156:159]
    v_xor_b32_e64 v74, v26, v74
    v_mfma_f32_16x16x32_bf16 v[160:163], v[208:211], v[76:79], v[160:163]
    v_xor_b32_e64 v75, v26, v75
    v_mfma_f32_16x16x32_bf16 v[164:167], v[196:199], v[104:107], v[164:167]
    v_xor_b32_e64 v100, v27, v100
    v_mfma_f32_16x16x32_bf16 v[168:171], v[200:203], v[104:107], v[168:171]
    v_xor_b32_e64 v101, v27, v101
    v_mfma_f32_16x16x32_bf16 v[172:175], v[204:207], v[104:107], v[172:175]
    v_xor_b32_e64 v102, v27, v102
    v_mfma_f32_16x16x32_bf16 v[176:179], v[208:211], v[104:107], v[176:179]
    v_xor_b32_e64 v103, v27, v103
    v_mfma_f32_16x16x32_bf16 v[180:183], v[196:199], v[132:135], v[180:183]
    v_xor_b32_e64 v128, v26, v128
    v_mfma_f32_16x16x32_bf16 v[184:187], v[200:203], v[132:135], v[184:187]
    v_xor_b32_e64 v129, v26, v129
    v_mfma_f32_16x16x32_bf16 v[188:191], v[204:207], v[132:135], v[188:191]
    v_xor_b32_e64 v130, v26, v130
    v_mfma_f32_16x16x32_bf16 v[192:195], v[208:211], v[132:135], v[192:195]
    v_xor_b32_e64 v131, v26, v131
    ds_read_b128 v[196:199], v24 offset:24576
    ds_read_b128 v[200:203], v24 offset:26624
    ds_read_b128 v[204:207], v24 offset:28672
    ds_read_b128 v[208:211], v24 offset:30720
    s_waitcnt lgkmcnt(8)
    v_mfma_f32_16x16x32_bf16 v[148:151], v[212:215], v[80:83], v[148:151]
    v_xor_b32 v76, v26, v76
    v_mfma_f32_16x16x32_bf16 v[152:155], v[216:219], v[80:83], v[152:155]
    v_xor_b32_e64 v77, v26, v77
    v_mfma_f32_16x16x32_bf16 v[156:159], v[220:223], v[80:83], v[156:159]
    v_xor_b32_e64 v78, v26, v78
    v_mfma_f32_16x16x32_bf16 v[160:163], v[224:227], v[80:83], v[160:163]
    v_xor_b32_e64 v79, v26, v79
    v_mfma_f32_16x16x32_bf16 v[164:167], v[212:215], v[108:111], v[164:167]
    v_xor_b32_e64 v104, v27, v104
    v_mfma_f32_16x16x32_bf16 v[168:171], v[216:219], v[108:111], v[168:171]
    v_xor_b32_e64 v105, v27, v105
    v_mfma_f32_16x16x32_bf16 v[172:175], v[220:223], v[108:111], v[172:175]
    v_xor_b32_e64 v106, v27, v106
    v_mfma_f32_16x16x32_bf16 v[176:179], v[224:227], v[108:111], v[176:179]
    v_xor_b32_e64 v107, v27, v107
    v_mfma_f32_16x16x32_bf16 v[180:183], v[212:215], v[136:139], v[180:183]
    v_xor_b32_e64 v132, v26, v132
    v_mfma_f32_16x16x32_bf16 v[184:187], v[216:219], v[136:139], v[184:187]
    v_xor_b32_e64 v133, v26, v133
    v_mfma_f32_16x16x32_bf16 v[188:191], v[220:223], v[136:139], v[188:191]
    v_xor_b32_e64 v134, v26, v134
    v_mfma_f32_16x16x32_bf16 v[192:195], v[224:227], v[136:139], v[192:195]
    v_xor_b32_e64 v135, v26, v135
    ds_read_b128 v[212:215], v25 offset:24576
    ds_read_b128 v[216:219], v25 offset:26624
    ds_read_b128 v[220:223], v25 offset:28672
    ds_read_b128 v[224:227], v25 offset:30720
    s_waitcnt lgkmcnt(8)
    v_mfma_f32_16x16x32_bf16 v[148:151], v[228:231], v[84:87], v[148:151]
    v_xor_b32 v80, v26, v80
    v_mfma_f32_16x16x32_bf16 v[152:155], v[232:235], v[84:87], v[152:155]
    v_xor_b32_e64 v81, v26, v81
    v_mfma_f32_16x16x32_bf16 v[156:159], v[236:239], v[84:87], v[156:159]
    v_xor_b32_e64 v82, v26, v82
    v_mfma_f32_16x16x32_bf16 v[160:163], v[240:243], v[84:87], v[160:163]
    v_xor_b32_e64 v83, v26, v83
    v_mfma_f32_16x16x32_bf16 v[164:167], v[228:231], v[112:115], v[164:167]
    v_xor_b32_e64 v108, v27, v108
    v_mfma_f32_16x16x32_bf16 v[168:171], v[232:235], v[112:115], v[168:171]
    v_xor_b32_e64 v109, v27, v109
    v_mfma_f32_16x16x32_bf16 v[172:175], v[236:239], v[112:115], v[172:175]
    v_xor_b32_e64 v110, v27, v110
    v_mfma_f32_16x16x32_bf16 v[176:179], v[240:243], v[112:115], v[176:179]
    v_xor_b32_e64 v111, v27, v111
    v_mfma_f32_16x16x32_bf16 v[180:183], v[228:231], v[140:143], v[180:183]
    v_xor_b32_e64 v136, v26, v136
    v_mfma_f32_16x16x32_bf16 v[184:187], v[232:235], v[140:143], v[184:187]
    v_xor_b32_e64 v137, v26, v137
    v_mfma_f32_16x16x32_bf16 v[188:191], v[236:239], v[140:143], v[188:191]
    v_xor_b32_e64 v138, v26, v138
    v_mfma_f32_16x16x32_bf16 v[192:195], v[240:243], v[140:143], v[192:195]
    v_xor_b32_e64 v139, v26, v139
    ds_read_b128 v[228:231], v24 offset:32768
    ds_read_b128 v[232:235], v24 offset:34816
    ds_read_b128 v[236:239], v24 offset:36864
    ds_read_b128 v[240:243], v24 offset:38912
    s_waitcnt lgkmcnt(8)
    v_mfma_f32_16x16x32_bf16 v[148:151], v[196:199], v[88:91], v[148:151]
    v_xor_b32 v84, v26, v84
    v_mfma_f32_16x16x32_bf16 v[152:155], v[200:203], v[88:91], v[152:155]
    v_xor_b32_e64 v85, v26, v85
    v_mfma_f32_16x16x32_bf16 v[156:159], v[204:207], v[88:91], v[156:159]
    v_xor_b32_e64 v86, v26, v86
    v_mfma_f32_16x16x32_bf16 v[160:163], v[208:211], v[88:91], v[160:163]
    v_xor_b32_e64 v87, v26, v87
    v_mfma_f32_16x16x32_bf16 v[164:167], v[196:199], v[116:119], v[164:167]
    v_xor_b32_e64 v112, v27, v112
    v_mfma_f32_16x16x32_bf16 v[168:171], v[200:203], v[116:119], v[168:171]
    v_xor_b32_e64 v113, v27, v113
    v_mfma_f32_16x16x32_bf16 v[172:175], v[204:207], v[116:119], v[172:175]
    v_xor_b32_e64 v114, v27, v114
    v_mfma_f32_16x16x32_bf16 v[176:179], v[208:211], v[116:119], v[176:179]
    v_xor_b32_e64 v115, v27, v115
    v_mfma_f32_16x16x32_bf16 v[180:183], v[196:199], v[144:147], v[180:183]
    v_xor_b32_e64 v140, v26, v140
    v_mfma_f32_16x16x32_bf16 v[184:187], v[200:203], v[144:147], v[184:187]
    v_xor_b32_e64 v141, v26, v141
    v_mfma_f32_16x16x32_bf16 v[188:191], v[204:207], v[144:147], v[188:191]
    v_xor_b32_e64 v142, v26, v142
    v_mfma_f32_16x16x32_bf16 v[192:195], v[208:211], v[144:147], v[192:195]
    v_xor_b32_e64 v143, v26, v143
    ds_read_b128 v[196:199], v25 offset:32768
    ds_read_b128 v[200:203], v25 offset:34816
    ds_read_b128 v[204:207], v25 offset:36864
    ds_read_b128 v[208:211], v25 offset:38912
    s_waitcnt lgkmcnt(8)
    v_mfma_f32_16x16x32_bf16 v[148:151], v[212:215], v[64:67], v[148:151]
    v_xor_b32 v88, v26, v88
    v_mfma_f32_16x16x32_bf16 v[152:155], v[216:219], v[64:67], v[152:155]
    v_xor_b32_e64 v89, v26, v89
    v_mfma_f32_16x16x32_bf16 v[156:159], v[220:223], v[64:67], v[156:159]
    v_xor_b32_e64 v90, v26, v90
    v_mfma_f32_16x16x32_bf16 v[160:163], v[224:227], v[64:67], v[160:163]
    v_xor_b32_e64 v91, v26, v91
    v_mfma_f32_16x16x32_bf16 v[164:167], v[212:215], v[92:95], v[164:167]
    v_xor_b32_e64 v116, v27, v116
    v_mfma_f32_16x16x32_bf16 v[168:171], v[216:219], v[92:95], v[168:171]
    v_xor_b32_e64 v117, v27, v117
    v_mfma_f32_16x16x32_bf16 v[172:175], v[220:223], v[92:95], v[172:175]
    v_xor_b32_e64 v118, v27, v118
    v_mfma_f32_16x16x32_bf16 v[176:179], v[224:227], v[92:95], v[176:179]
    v_xor_b32_e64 v119, v27, v119
    v_mfma_f32_16x16x32_bf16 v[180:183], v[212:215], v[120:123], v[180:183]
    v_xor_b32_e64 v144, v26, v144
    v_mfma_f32_16x16x32_bf16 v[184:187], v[216:219], v[120:123], v[184:187]
    v_xor_b32_e64 v145, v26, v145
    v_mfma_f32_16x16x32_bf16 v[188:191], v[220:223], v[120:123], v[188:191]
    v_xor_b32_e64 v146, v26, v146
    v_mfma_f32_16x16x32_bf16 v[192:195], v[224:227], v[120:123], v[192:195]
    v_xor_b32 v147, v26, v147
    ds_read_b128 v[212:215], v24 offset:40960
    ds_read_b128 v[216:219], v24 offset:43008
    ds_read_b128 v[220:223], v24 offset:45056
    ds_read_b128 v[224:227], v24 offset:47104
    s_waitcnt lgkmcnt(8)
    v_mfma_f32_16x16x32_bf16 v[148:151], v[228:231], v[68:71], v[148:151]
    v_mfma_f32_16x16x32_bf16 v[152:155], v[232:235], v[68:71], v[152:155]
    v_mfma_f32_16x16x32_bf16 v[156:159], v[236:239], v[68:71], v[156:159]
    v_mfma_f32_16x16x32_bf16 v[160:163], v[240:243], v[68:71], v[160:163]
    v_mfma_f32_16x16x32_bf16 v[164:167], v[228:231], v[96:99], v[164:167]
    v_mfma_f32_16x16x32_bf16 v[168:171], v[232:235], v[96:99], v[168:171]
    v_mfma_f32_16x16x32_bf16 v[172:175], v[236:239], v[96:99], v[172:175]
    v_mfma_f32_16x16x32_bf16 v[176:179], v[240:243], v[96:99], v[176:179]
    v_mfma_f32_16x16x32_bf16 v[180:183], v[228:231], v[124:127], v[180:183]
    v_mfma_f32_16x16x32_bf16 v[184:187], v[232:235], v[124:127], v[184:187]
    v_mfma_f32_16x16x32_bf16 v[188:191], v[236:239], v[124:127], v[188:191]
    v_mfma_f32_16x16x32_bf16 v[192:195], v[240:243], v[124:127], v[192:195]
    ds_read_b128 v[228:231], v25 offset:40960
    ds_read_b128 v[232:235], v25 offset:43008
    ds_read_b128 v[236:239], v25 offset:45056
    ds_read_b128 v[240:243], v25 offset:47104
    s_waitcnt lgkmcnt(8)
    v_mfma_f32_16x16x32_bf16 v[148:151], v[196:199], v[72:75], v[148:151]
    v_mfma_f32_16x16x32_bf16 v[152:155], v[200:203], v[72:75], v[152:155]
    v_mfma_f32_16x16x32_bf16 v[156:159], v[204:207], v[72:75], v[156:159]
    v_mfma_f32_16x16x32_bf16 v[160:163], v[208:211], v[72:75], v[160:163]
    v_mfma_f32_16x16x32_bf16 v[164:167], v[196:199], v[100:103], v[164:167]
    v_mfma_f32_16x16x32_bf16 v[168:171], v[200:203], v[100:103], v[168:171]
    v_mfma_f32_16x16x32_bf16 v[172:175], v[204:207], v[100:103], v[172:175]
    v_mfma_f32_16x16x32_bf16 v[176:179], v[208:211], v[100:103], v[176:179]
    v_mfma_f32_16x16x32_bf16 v[180:183], v[196:199], v[128:131], v[180:183]
    v_mfma_f32_16x16x32_bf16 v[184:187], v[200:203], v[128:131], v[184:187]
    v_mfma_f32_16x16x32_bf16 v[188:191], v[204:207], v[128:131], v[188:191]
    v_mfma_f32_16x16x32_bf16 v[192:195], v[208:211], v[128:131], v[192:195]
    ds_read_b128 v[196:199], v24 offset:49152
    ds_read_b128 v[200:203], v24 offset:51200
    ds_read_b128 v[204:207], v24 offset:53248
    ds_read_b128 v[208:211], v24 offset:55296
    s_waitcnt lgkmcnt(8)
    v_mfma_f32_16x16x32_bf16 v[148:151], v[212:215], v[76:79], v[148:151]
    v_mfma_f32_16x16x32_bf16 v[152:155], v[216:219], v[76:79], v[152:155]
    v_mfma_f32_16x16x32_bf16 v[156:159], v[220:223], v[76:79], v[156:159]
    v_mfma_f32_16x16x32_bf16 v[160:163], v[224:227], v[76:79], v[160:163]
    v_mfma_f32_16x16x32_bf16 v[164:167], v[212:215], v[104:107], v[164:167]
    v_mfma_f32_16x16x32_bf16 v[168:171], v[216:219], v[104:107], v[168:171]
    v_mfma_f32_16x16x32_bf16 v[172:175], v[220:223], v[104:107], v[172:175]
    v_mfma_f32_16x16x32_bf16 v[176:179], v[224:227], v[104:107], v[176:179]
    v_mfma_f32_16x16x32_bf16 v[180:183], v[212:215], v[132:135], v[180:183]
    v_mfma_f32_16x16x32_bf16 v[184:187], v[216:219], v[132:135], v[184:187]
    v_mfma_f32_16x16x32_bf16 v[188:191], v[220:223], v[132:135], v[188:191]
    v_mfma_f32_16x16x32_bf16 v[192:195], v[224:227], v[132:135], v[192:195]
    ds_read_b128 v[212:215], v25 offset:49152
    ds_read_b128 v[216:219], v25 offset:51200
    ds_read_b128 v[220:223], v25 offset:53248
    ds_read_b128 v[224:227], v25 offset:55296
    s_waitcnt lgkmcnt(8)
    v_mfma_f32_16x16x32_bf16 v[148:151], v[228:231], v[80:83], v[148:151]
    v_mfma_f32_16x16x32_bf16 v[152:155], v[232:235], v[80:83], v[152:155]
    v_mfma_f32_16x16x32_bf16 v[156:159], v[236:239], v[80:83], v[156:159]
    v_mfma_f32_16x16x32_bf16 v[160:163], v[240:243], v[80:83], v[160:163]
    v_mfma_f32_16x16x32_bf16 v[164:167], v[228:231], v[108:111], v[164:167]
    v_mfma_f32_16x16x32_bf16 v[168:171], v[232:235], v[108:111], v[168:171]
    v_mfma_f32_16x16x32_bf16 v[172:175], v[236:239], v[108:111], v[172:175]
    v_mfma_f32_16x16x32_bf16 v[176:179], v[240:243], v[108:111], v[176:179]
    v_mfma_f32_16x16x32_bf16 v[180:183], v[228:231], v[136:139], v[180:183]
    v_mfma_f32_16x16x32_bf16 v[184:187], v[232:235], v[136:139], v[184:187]
    v_mfma_f32_16x16x32_bf16 v[188:191], v[236:239], v[136:139], v[188:191]
    v_mfma_f32_16x16x32_bf16 v[192:195], v[240:243], v[136:139], v[192:195]
    s_waitcnt lgkmcnt(4)
    v_mfma_f32_16x16x32_bf16 v[148:151], v[196:199], v[84:87], v[148:151]
    v_mfma_f32_16x16x32_bf16 v[152:155], v[200:203], v[84:87], v[152:155]
    v_mfma_f32_16x16x32_bf16 v[156:159], v[204:207], v[84:87], v[156:159]
    v_mfma_f32_16x16x32_bf16 v[160:163], v[208:211], v[84:87], v[160:163]
    v_mfma_f32_16x16x32_bf16 v[164:167], v[196:199], v[112:115], v[164:167]
    v_mfma_f32_16x16x32_bf16 v[168:171], v[200:203], v[112:115], v[168:171]
    v_mfma_f32_16x16x32_bf16 v[172:175], v[204:207], v[112:115], v[172:175]
    v_mfma_f32_16x16x32_bf16 v[176:179], v[208:211], v[112:115], v[176:179]
    v_mfma_f32_16x16x32_bf16 v[180:183], v[196:199], v[140:143], v[180:183]
    v_mfma_f32_16x16x32_bf16 v[184:187], v[200:203], v[140:143], v[184:187]
    v_mfma_f32_16x16x32_bf16 v[188:191], v[204:207], v[140:143], v[188:191]
    v_mfma_f32_16x16x32_bf16 v[192:195], v[208:211], v[140:143], v[192:195]
    s_waitcnt lgkmcnt(0)
    v_mfma_f32_16x16x32_bf16 v[148:151], v[212:215], v[88:91], v[148:151]
    v_mfma_f32_16x16x32_bf16 v[152:155], v[216:219], v[88:91], v[152:155]
    v_mfma_f32_16x16x32_bf16 v[156:159], v[220:223], v[88:91], v[156:159]
    v_mfma_f32_16x16x32_bf16 v[160:163], v[224:227], v[88:91], v[160:163]
    v_mfma_f32_16x16x32_bf16 v[164:167], v[212:215], v[116:119], v[164:167]
    v_mfma_f32_16x16x32_bf16 v[168:171], v[216:219], v[116:119], v[168:171]
    v_mfma_f32_16x16x32_bf16 v[172:175], v[220:223], v[116:119], v[172:175]
    v_mfma_f32_16x16x32_bf16 v[176:179], v[224:227], v[116:119], v[176:179]
    v_mfma_f32_16x16x32_bf16 v[180:183], v[212:215], v[144:147], v[180:183]
    v_mfma_f32_16x16x32_bf16 v[184:187], v[216:219], v[144:147], v[184:187]
    v_mfma_f32_16x16x32_bf16 v[188:191], v[220:223], v[144:147], v[188:191]
    v_mfma_f32_16x16x32_bf16 v[192:195], v[224:227], v[144:147], v[192:195]
    s_setprio 2
    v_cvt_pk_bf16_f32 v196, v148, v149
    v_cvt_pk_bf16_f32 v197, v150, v151
    v_cvt_pk_bf16_f32 v198, v152, v153
    v_cvt_pk_bf16_f32 v199, v154, v155
    v_cvt_pk_bf16_f32 v200, v156, v157
    v_cvt_pk_bf16_f32 v201, v158, v159
    v_cvt_pk_bf16_f32 v202, v160, v161
    v_cvt_pk_bf16_f32 v203, v162, v163
    v_cvt_pk_bf16_f32 v204, v164, v165
    v_cvt_pk_bf16_f32 v205, v166, v167
    v_cvt_pk_bf16_f32 v206, v168, v169
    v_cvt_pk_bf16_f32 v207, v170, v171
    v_cvt_pk_bf16_f32 v208, v172, v173
    v_cvt_pk_bf16_f32 v209, v174, v175
    v_cvt_pk_bf16_f32 v210, v176, v177
    v_cvt_pk_bf16_f32 v211, v178, v179
    v_cvt_pk_bf16_f32 v212, v180, v181
    v_cvt_pk_bf16_f32 v213, v182, v183
    v_cvt_pk_bf16_f32 v214, v184, v185
    v_cvt_pk_bf16_f32 v215, v186, v187
    v_cvt_pk_bf16_f32 v216, v188, v189
    v_cvt_pk_bf16_f32 v217, v190, v191
    v_cvt_pk_bf16_f32 v218, v192, v193
    v_cvt_pk_bf16_f32 v219, v194, v195
    v_mfma_f32_16x16x32_bf16 v[64:67], v[40:43], v[196:199], 0
    v_mfma_f32_16x16x32_bf16 v[72:75], v[40:43], v[200:203], 0
    v_mfma_f32_16x16x32_bf16 v[80:83], v[40:43], v[204:207], 0
    v_mfma_f32_16x16x32_bf16 v[88:91], v[40:43], v[208:211], 0
    v_mfma_f32_16x16x32_bf16 v[96:99], v[40:43], v[212:215], 0
    v_mfma_f32_16x16x32_bf16 v[104:107], v[40:43], v[216:219], 0
    v_mfma_f32_16x16x32_bf16 v[68:71], v[44:47], v[196:199], 0
    v_mfma_f32_16x16x32_bf16 v[76:79], v[44:47], v[200:203], 0
    v_mfma_f32_16x16x32_bf16 v[84:87], v[44:47], v[204:207], 0
    v_mfma_f32_16x16x32_bf16 v[92:95], v[44:47], v[208:211], 0
    v_mfma_f32_16x16x32_bf16 v[100:103], v[44:47], v[212:215], 0
    v_mfma_f32_16x16x32_bf16 v[108:111], v[44:47], v[216:219], 0
    v_cvt_pk_bf16_f32 v148, v65, -v64
    v_cvt_pk_bf16_f32 v164, v73, -v72
    v_cvt_pk_bf16_f32 v149, v81, -v80
    v_cvt_pk_bf16_f32 v165, v89, -v88
    v_cvt_pk_bf16_f32 v150, v97, -v96
    v_cvt_pk_bf16_f32 v166, v105, -v104
    v_cvt_pk_bf16_f32 v152, v67, -v66
    v_cvt_pk_bf16_f32 v168, v75, -v74
    v_cvt_pk_bf16_f32 v153, v83, -v82
    v_cvt_pk_bf16_f32 v169, v91, -v90
    v_cvt_pk_bf16_f32 v154, v99, -v98
    v_cvt_pk_bf16_f32 v170, v107, -v106
    v_cvt_pk_bf16_f32 v156, v69, -v68
    v_cvt_pk_bf16_f32 v172, v77, -v76
    v_cvt_pk_bf16_f32 v157, v85, -v84
    v_cvt_pk_bf16_f32 v173, v93, -v92
    v_cvt_pk_bf16_f32 v158, v101, -v100
    v_cvt_pk_bf16_f32 v174, v109, -v108
    v_cvt_pk_bf16_f32 v160, v71, -v70
    v_cvt_pk_bf16_f32 v176, v79, -v78
    v_cvt_pk_bf16_f32 v161, v87, -v86
    v_cvt_pk_bf16_f32 v177, v95, -v94
    v_cvt_pk_bf16_f32 v162, v103, -v102
    v_cvt_pk_bf16_f32 v178, v111, -v110
    s_mov_b32 s42, 0x100000
spin_50:
    ds_read_b32 v30, v19 offset:0
    s_waitcnt lgkmcnt(0)
    v_cmp_gt_u32 vcc, 1, v30
    s_sub_u32 s42, s42, 1
    s_cbranch_vccz spinx_51
    s_cbranch_scc0 spin_50
spinx_51:
    s_mov_b32 s1, 0
    s_atomic_add s1, s[46:47], s7 glc
    s_mov_b32 s48, s24
    s_mov_b32 s49, s25
    s_add_u32 s39, s78, 3936256
    buffer_store_dwordx3 v[148:150], v55, s[24:27], s39 offen sc1
    s_add_u32 s39, s78, 4050944
    buffer_store_dwordx3 v[152:154], v55, s[24:27], s39 offen sc1
    s_add_u32 s39, s78, 4853760
    buffer_store_dwordx3 v[156:158], v55, s[24:27], s39 offen sc1
    s_add_u32 s39, s78, 4968448
    buffer_store_dwordx3 v[160:162], v55, s[24:27], s39 offen sc1
    s_add_u32 s39, s78, 3938048
    buffer_store_dwordx3 v[164:166], v55, s[24:27], s39 offen sc1
    s_add_u32 s39, s78, 4052736
    buffer_store_dwordx3 v[168:170], v55, s[24:27], s39 offen sc1
    s_add_u32 s39, s78, 4855552
    buffer_store_dwordx3 v[172:174], v55, s[24:27], s39 offen sc1
    s_add_u32 s39, s78, 4970240
    buffer_store_dwordx3 v[176:178], v55, s[24:27], s39 offen sc1
    s_waitcnt lgkmcnt(0)
    s_cmp_ge_u32 s1, s8
    s_cbranch_scc1 L_A_polled
    s_branch L_A_stage
L_end:
    s_endpgm
.section .rodata,"a"
.p2align 6
.amdhsa_kernel concat_heads__spectral_fnet__sliding_block__prompt_kernel
  .amdhsa_next_free_vgpr 256
  .amdhsa_next_free_sgpr 102
  .amdhsa_accum_offset 256
  .amdhsa_group_segment_fixed_size 0
  .amdhsa_kernarg_size 88
  .amdhsa_user_sgpr_count 2
  .amdhsa_user_sgpr_kernarg_segment_ptr 1
  .amdhsa_system_sgpr_workgroup_id_x 1
.end_amdhsa_kernel
```
